```python
import torch

def _softmax(x, axis=-1):
    return torch.softmax(x, dim=axis)

def _gelu(x):
    return torch.nn.functional.gelu(x, approximate='tanh')

def _silu(x):
    return torch.nn.functional.silu(x)

def _sigmoid(x):
    return torch.sigmoid(x)

def _layernorm(x, axis=-1, eps=1e-05):
    m = x.mean(dim=axis, keepdim=True)
    v = x.var(dim=axis, keepdim=True, unbiased=False)
    return (x - m) / torch.sqrt(v + eps)

def _scatter_add(tgt, idx, src, axis=0):
    return tgt.clone().index_add_(axis, idx, src)

def _segment_sum(src, seg, n):
    out = torch.zeros((n,) + src.shape[1:], dtype=src.dtype)
    return out.index_add_(0, seg, src)

def _pad(x, pw):
    flat = tuple((v for pair in reversed(pw) for v in pair))
    return torch.nn.functional.pad(x, flat)
kernel_name = 'adaLN_cond__mha_block_cached__glu_gated_geglu__decode'

def setup_inputs():

    _w = lambda a: (lambda t: t.to(torch.bfloat16) if t.is_floating_point() else t)(torch.as_tensor(a))

    def _A_setup():
        B, Sq, D = (1, 1, 640)
        H, Sk, Dh = (32, 32768, 192)
        return {'x': _w((lambda *s: torch.randn(*s, dtype=torch.bfloat16) * 0.05)(B, Sq, D)), 'k_cache': _w((lambda *s: torch.randn(*s, dtype=torch.bfloat16) * 0.8)(B, H, Sk, Dh)), 'v_cache': _w((lambda *s: torch.randn(*s, dtype=torch.bfloat16) * 3.2)(B, H, Sk, Dh)), 'wq': _w((lambda *s: torch.randn(*s, dtype=torch.bfloat16) * 0.8)(D, H * Dh) * D ** (-0.5)), 'wo': _w((lambda *s: torch.randn(*s, dtype=torch.bfloat16) * 3.2)(H * Dh, D) * (H * Dh) ** (-0.5))}
    _A_in = _A_setup()

    def _B_setup():
        B, S, Dm, Df = (1, 1, 640, 1536)
        return {'x': _w((lambda *s: torch.randn(*s, dtype=torch.bfloat16) * 0.05)(B, S, Dm)), 'w_gate': _w((lambda *s: torch.randn(*s, dtype=torch.bfloat16) * 3.2)(Dm, Df) * Dm ** (-0.5)), 'w_up': _w((lambda *s: torch.randn(*s, dtype=torch.bfloat16) * 3.2)(Dm, Df) * Dm ** (-0.5)), 'w_down': _w((lambda *s: torch.randn(*s, dtype=torch.bfloat16) * 3.2)(Df, Dm) * Df ** (-0.5))}
    _B_in = _B_setup()
    return {'A_x': _A_in['x'], 'A_k_cache': _A_in['k_cache'], 'A_v_cache': _A_in['v_cache'], 'A_wq': _A_in['wq'], 'A_wo': _A_in['wo'], 'B_x': _B_in['x'], 'B_w_gate': _B_in['w_gate'], 'B_w_up': _B_in['w_up'], 'B_w_down': _B_in['w_down'], 'c': _w((lambda *s: torch.randn(*s, dtype=torch.bfloat16) * 0.4)(1, 640) * 8.0), 'w_mod': _w((lambda *s: torch.randn(*s, dtype=torch.bfloat16) * 0.4)(640, 6 * 640) * 640 ** (-0.5) * 8.0)}

def reference(A_x, A_k_cache, A_v_cache, A_wq, A_wo, B_x, B_w_gate, B_w_up, B_w_down, c, w_mod):

    def _A_ref(x, k_cache, v_cache, wq, wo):
        B, Sq, D = x.shape
        H, Dh = (32, 192)
        q = (lambda x, *d: x.permute(*d))((x @ wq).reshape(B, Sq, H, Dh), 0, 2, 1, 3)
        scores = torch.einsum('bhqd,bhkd->bhqk', q, k_cache) * Dh ** (-0.5)
        p = _softmax(scores, axis=-1)
        o = torch.einsum('bhqk,bhkd->bhqd', p, v_cache)
        return (lambda x, *d: x.permute(*d))(o, 0, 2, 1, 3).reshape(B, Sq, H * Dh) @ wo

    def _B_ref(x, w_gate, w_up, w_down):
        g = torch.einsum('bsd,df->bsf', x, w_gate)
        u = torch.einsum('bsd,df->bsf', x, w_up)
        h = _gelu(g) * u
        return torch.einsum('bsf,fd->bsd', h, w_down)
    x = A_x
    mod = (_silu(c) @ w_mod).reshape(c.shape[0], 6, 1, -1)
    sa, ca, ga, sb, cb, gb = (mod[:, 0].clone(), mod[:, 1].clone(), mod[:, 2].clone(), mod[:, 3].clone(), mod[:, 4].clone(), mod[:, 5].clone())
    h = _layernorm(x, axis=-1) * (1 + ca) + sa
    x = x + ga * _A_ref(h, A_k_cache, A_v_cache, A_wq, A_wo)
    h = _layernorm(x, axis=-1) * (1 + cb) + sb
    x = x + gb * _B_ref(h, B_w_gate, B_w_up, B_w_down)
    return x
```

```asm
; @launch grid=(256,1,1) block=(512,1,1) lds=159744
.amdgcn_target "amdgcn-amd-amdhsa--gfx950"
.text
.globl adaLN_cond__mha_block_cached__glu_gated_geglu__decode_kernel
.p2align 8
.type adaLN_cond__mha_block_cached__glu_gated_geglu__decode_kernel,@function
adaLN_cond__mha_block_cached__glu_gated_geglu__decode_kernel:
  s_cmp_ge_u32 s2, 256
  s_cbranch_scc1 L_exit
  s_load_dwordx16 s[4:19], s[0:1], 0
  s_load_dwordx8 s[20:27], s[0:1], 64
  s_load_dwordx4 s[28:31], s[0:1], 96
  v_lshrrev_b32 v1, 6, v0
  v_and_b32 v0, 63, v0
  s_lshr_b32 s48, s2, 3
  v_readfirstlane_b32 s3, v1
  s_and_b32 s49, s2, 7
  s_mov_b32 s68, 0x200000
  s_sub_u32 s63, s49, s48
  s_and_b32 s63, s63, 7
  s_cmp_eq_u32 s63, 3
  s_cselect_b32 s62, 1, 0
  s_cmp_lt_u32 s48, 20
  s_cselect_b32 s62, s62, 0
  s_cmp_lt_u32 s63, 3
  s_cselect_b32 s62, 2, s62
  s_cmp_ge_u32 s3, 4
  s_cbranch_scc1 L_stream
  s_setprio 3
  v_lshrrev_b32 v3, 3, v0
  v_and_b32 v4, 7, v0
  v_lshrrev_b32 v5, 4, v0
  v_and_b32 v6, 15, v0
  v_lshrrev_b32 v7, 2, v6
  v_lshl_add_u32 v7, v5, 3, v7
  v_lshlrev_b32 v7, 7, v7
  v_and_b32 v8, 3, v6
  v_lshl_add_u32 v7, v8, 3, v7
  v_lshlrev_b32 v11, 2, v0
  v_mov_b32 v12, -1
  v_mov_b32 v13, -1
  s_cmp_eq_u32 s3, 2
  s_cbranch_scc1 L_init2
  s_cmp_eq_u32 s3, 1
  s_cbranch_scc0 L_init3
  s_mul_i32 s52, s48, 5
  s_add_u32 s52, s52, s49
  s_lshl_b32 s52, s52, 2
  v_lshlrev_b32 v10, 5, v0
  v_add_u32 v10, s52, v10
  v_and_b32 v10, 2047, v10
  v_cmp_gt_u32 vcc, 52, v0
  s_nop 1
  v_cndmask_b32 v10, v12, v10, vcc
  ds_write_b32 v11, v10 offset:128
  ds_write_b32 v11, v12 offset:384
  ds_write_b32 v11, v12 offset:640
  ds_write_b32 v11, v12 offset:896
  s_branch L_init_done
L_init2:
  v_lshlrev_b32 v10, 3, v0
  ds_write_b64 v10, v[12:13] offset:1152
  s_branch L_init_done
L_init3:
  v_and_b32 v10, 31, v0
  v_lshlrev_b32 v10, 2, v10
  v_mov_b32 v12, 0
  ds_write_b32 v10, v12 offset:0
L_init_done:
  v_min_u32 v13, 39, v0
  s_mul_i32 s52, s3, 320
  v_lshl_add_u32 v10, v13, 3, s52
  s_lshl_b32 s58, s3, 2
  s_waitcnt lgkmcnt(0)
  s_load_dword s51, s[30:31], 0
  s_mov_b32 s32, s30
  s_mov_b32 s33, s31
  s_mov_b32 s34, 1048576
  s_mov_b32 s35, 0x20000
  s_cmp_eq_u32 s62, 0
  s_cbranch_scc1 L_issued
  s_mov_b32 s39, 0x20000
  s_cmp_eq_u32 s62, 2
  s_cbranch_scc1 L_pq
  s_mov_b32 s44, s22
  s_mov_b32 s45, s23
  s_mov_b32 s46, 1280
  s_mov_b32 s47, 0x20000
  buffer_load_dwordx2 v[12:13], v10, s[44:47], 0 offen
  s_mov_b32 s36, s24
  s_mov_b32 s37, s25
  s_mov_b32 s38, 4915200
  s_mov_b32 s57, 7680
  s_lshl_b32 s56, s48, 7
  s_lshl_b32 s59, s48, 8
  s_add_u32 s59, s59, 16384
  s_branch L_pdma
L_pq:
  s_mov_b32 s40, s4
  s_mov_b32 s41, s5
  s_mov_b32 s42, 1280
  s_mov_b32 s43, 0x20000
  buffer_load_dword v24, v11, s[40:43], 0 offen offset:0
  buffer_load_dword v25, v11, s[40:43], 0 offen offset:256
  buffer_load_dword v26, v11, s[40:43], 0 offen offset:512
  buffer_load_dword v27, v11, s[40:43], 0 offen offset:768
  buffer_load_dword v28, v11, s[40:43], 0 offen offset:1024
  buffer_load_dwordx2 v[30:31], v10, s[40:43], 0 offen
  s_mov_b32 s36, s10
  s_mov_b32 s37, s11
  s_mov_b32 s38, 7864320
  s_mov_b32 s57, 12288
  s_mul_i32 s53, s48, 3
  s_add_u32 s53, s53, s63
  s_lshl_b32 s56, s53, 7
  s_lshl_b32 s59, s53, 8
  s_add_u32 s59, s59, 32768
  s_or_b32 s52, s63, s3
  s_cmp_lg_u32 s52, 0
  s_cbranch_scc1 L_pdma
  s_lshl_b32 s52, s48, 8
  s_add_u32 s52, s52, 4096
  v_mov_b32 v9, 0
  s_mov_b64 exec, 1
  buffer_store_dword v9, v9, s[32:35], s52 offen sc1
  s_mov_b64 exec, -1
L_pdma:
  v_mul_lo_u32 v9, s57, v3
  v_lshl_add_u32 v9, v4, 4, v9
  s_lshl_b32 s52, s57, 3
  s_mul_i32 s52, s52, s3
  s_add_u32 s56, s56, s52
  s_lshl_b32 s57, s57, 5
  s_lshl_b32 s52, s3, 10
  s_add_u32 m0, s52, 12288
  s_mov_b32 s52, 20
L_mdma:
  buffer_load_dwordx4 v9, s[36:39], s56 offen nt lds
  s_add_u32 m0, m0, 4096
  s_add_u32 s56, s56, s57
  s_sub_u32 s52, s52, 1
  s_cmp_lg_u32 s52, 0
  s_cbranch_scc1 L_mdma
  s_lshl_b32 s52, s3, 6
  s_add_u32 s59, s59, s52
L_issued:
  s_barrier
  v_mov_b32 v47, s58
  v_mov_b32 v46, 1
  s_cmp_lg_u32 s62, 0
  s_cbranch_scc1 L_prod
  ds_write_b32 v47, v46 offset:48
  s_waitcnt lgkmcnt(0)
  s_mul_i32 s50, s51, 0x9E3779B1
  s_add_u32 s50, s50, 0x7F4A7C15
  s_branch L_qp
L_prod:
  s_waitcnt vmcnt(20)
  s_cmp_eq_u32 s62, 2
  s_cbranch_scc1 L_ln
  v_lshlrev_b32 v14, 16, v12
  v_and_b32 v15, 0xffff0000, v12
  v_lshlrev_b32 v16, 16, v13
  v_and_b32 v17, 0xffff0000, v13
  v_mul_f32 v18, 0xbfb8aa3b, v14
  v_exp_f32 v18, v18
  s_nop 0
  v_add_f32 v18, 1.0, v18
  v_rcp_f32 v19, v18
  s_nop 0
  v_mul_f32 v20, v14, v19
  v_fma_f32 v18, -v20, v18, v14
  v_fma_f32 v14, v18, v19, v20
  v_cmp_class_f32 vcc, v14, 3
  s_nop 1
  v_cndmask_b32 v14, v14, v20, vcc
  v_mul_f32 v18, 0xbfb8aa3b, v15
  v_exp_f32 v18, v18
  s_nop 0
  v_add_f32 v18, 1.0, v18
  v_rcp_f32 v19, v18
  s_nop 0
  v_mul_f32 v20, v15, v19
  v_fma_f32 v18, -v20, v18, v15
  v_fma_f32 v15, v18, v19, v20
  v_cmp_class_f32 vcc, v15, 3
  s_nop 1
  v_cndmask_b32 v15, v15, v20, vcc
  v_mul_f32 v18, 0xbfb8aa3b, v16
  v_exp_f32 v18, v18
  s_nop 0
  v_add_f32 v18, 1.0, v18
  v_rcp_f32 v19, v18
  s_nop 0
  v_mul_f32 v20, v16, v19
  v_fma_f32 v18, -v20, v18, v16
  v_fma_f32 v16, v18, v19, v20
  v_cmp_class_f32 vcc, v16, 3
  s_nop 1
  v_cndmask_b32 v16, v16, v20, vcc
  v_mul_f32 v18, 0xbfb8aa3b, v17
  v_exp_f32 v18, v18
  s_nop 0
  v_add_f32 v18, 1.0, v18
  v_rcp_f32 v19, v18
  s_nop 0
  v_mul_f32 v20, v17, v19
  v_fma_f32 v18, -v20, v18, v17
  v_fma_f32 v17, v18, v19, v20
  v_cmp_class_f32 vcc, v17, 3
  s_nop 1
  v_cndmask_b32 v17, v17, v20, vcc
  v_cvt_pk_bf16_f32 v12, v14, v15
  v_cvt_pk_bf16_f32 v13, v16, v17
  s_mov_b32 exec_hi, 0xff
  ds_write_b64 v10, v[12:13] offset:2048
  s_mov_b64 exec, -1
  s_branch L_pw
L_ln:
  v_lshlrev_b32 v32, 16, v24
  v_and_b32 v33, 0xffff0000, v24
  v_lshlrev_b32 v34, 16, v25
  v_and_b32 v35, 0xffff0000, v25
  v_lshlrev_b32 v36, 16, v26
  v_and_b32 v37, 0xffff0000, v26
  v_lshlrev_b32 v38, 16, v27
  v_and_b32 v39, 0xffff0000, v27
  v_lshlrev_b32 v40, 16, v28
  v_and_b32 v41, 0xffff0000, v28
  v_readfirstlane_b32 s52, v32
  s_nop 1
  v_subrev_f32 v32, s52, v32
  v_subrev_f32 v33, s52, v33
  v_subrev_f32 v34, s52, v34
  v_subrev_f32 v35, s52, v35
  v_subrev_f32 v36, s52, v36
  v_subrev_f32 v37, s52, v37
  v_subrev_f32 v38, s52, v38
  v_subrev_f32 v39, s52, v39
  v_subrev_f32 v40, s52, v40
  v_subrev_f32 v41, s52, v41
  v_add_f32 v42, v32, v33
  v_mul_f32 v43, v32, v32
  v_fmac_f32 v43, v33, v33
  v_add_f32 v42, v42, v34
  v_fmac_f32 v43, v34, v34
  v_add_f32 v42, v42, v35
  v_fmac_f32 v43, v35, v35
  v_add_f32 v42, v42, v36
  v_fmac_f32 v43, v36, v36
  v_add_f32 v42, v42, v37
  v_fmac_f32 v43, v37, v37
  v_add_f32 v42, v42, v38
  v_fmac_f32 v43, v38, v38
  v_add_f32 v42, v42, v39
  v_fmac_f32 v43, v39, v39
  v_add_f32 v42, v42, v40
  v_fmac_f32 v43, v40, v40
  v_add_f32 v42, v42, v41
  v_fmac_f32 v43, v41, v41
  s_nop 0
  v_add_f32_dpp v42, v42, v42 row_ror:8 row_mask:0xf bank_mask:0xf
  v_add_f32_dpp v43, v43, v43 row_ror:8 row_mask:0xf bank_mask:0xf
  s_nop 0
  v_add_f32_dpp v42, v42, v42 row_ror:4 row_mask:0xf bank_mask:0xf
  v_add_f32_dpp v43, v43, v43 row_ror:4 row_mask:0xf bank_mask:0xf
  s_nop 0
  v_add_f32_dpp v42, v42, v42 row_ror:2 row_mask:0xf bank_mask:0xf
  v_add_f32_dpp v43, v43, v43 row_ror:2 row_mask:0xf bank_mask:0xf
  s_nop 0
  v_add_f32_dpp v42, v42, v42 row_ror:1 row_mask:0xf bank_mask:0xf
  v_add_f32_dpp v43, v43, v43 row_ror:1 row_mask:0xf bank_mask:0xf
  s_nop 0
  v_add_f32_dpp v42, v42, v42 row_bcast:15 row_mask:0xa bank_mask:0xf
  v_add_f32_dpp v43, v43, v43 row_bcast:15 row_mask:0xa bank_mask:0xf
  s_nop 0
  v_add_f32_dpp v42, v42, v42 row_bcast:31 row_mask:0xc bank_mask:0xf
  v_add_f32_dpp v43, v43, v43 row_bcast:31 row_mask:0xc bank_mask:0xf
  v_readlane_b32 s53, v42, 63
  v_readlane_b32 s54, v43, 63
  v_mov_b32 v44, 0x3acccccd
  v_mul_f32 v42, s53, v44
  v_mul_f32 v43, s54, v44
  v_fma_f32 v43, -v42, v42, v43
  v_add_f32 v42, s52, v42
  v_cvt_pk_bf16_f32 v43, v42, v43
  v_lshlrev_b32 v42, 16, v43
  v_and_b32 v43, 0xffff0000, v43
  v_add_f32 v43, 0x3727c5ac, v43
  v_cvt_pk_bf16_f32 v43, v43, v43
  v_and_b32 v43, 0xffff0000, v43
  v_sqrt_f32 v43, v43
  s_nop 0
  v_cvt_pk_bf16_f32 v43, v43, v43
  v_and_b32 v43, 0xffff0000, v43
  v_rcp_f32 v44, v43
  v_lshlrev_b32 v32, 16, v30
  v_and_b32 v33, 0xffff0000, v30
  v_lshlrev_b32 v34, 16, v31
  v_and_b32 v35, 0xffff0000, v31
  v_sub_f32 v32, v32, v42
  v_sub_f32 v33, v33, v42
  v_sub_f32 v34, v34, v42
  v_sub_f32 v35, v35, v42
  v_cvt_pk_bf16_f32 v33, v32, v33
  v_lshlrev_b32 v32, 16, v33
  v_and_b32 v33, 0xffff0000, v33
  v_cvt_pk_bf16_f32 v35, v34, v35
  v_lshlrev_b32 v34, 16, v35
  v_and_b32 v35, 0xffff0000, v35
  v_mul_f32 v28, v32, v44
  v_fma_f32 v45, -v28, v43, v32
  v_fmac_f32 v28, v45, v44
  v_mul_f32 v29, v33, v44
  v_fma_f32 v45, -v29, v43, v33
  v_fmac_f32 v29, v45, v44
  v_mul_f32 v30, v34, v44
  v_fma_f32 v45, -v30, v43, v34
  v_fmac_f32 v30, v45, v44
  v_mul_f32 v31, v35, v44
  v_fma_f32 v45, -v31, v43, v35
  v_fmac_f32 v31, v45, v44
  v_cvt_pk_bf16_f32 v29, v28, v29
  v_lshlrev_b32 v28, 16, v29
  v_and_b32 v29, 0xffff0000, v29
  v_cvt_pk_bf16_f32 v31, v30, v31
  v_lshlrev_b32 v30, 16, v31
  v_and_b32 v31, 0xffff0000, v31
L_pw:
  s_lshl_b32 s52, s3, 5
  v_add_u32 v14, s52, v7
  v_add_u32 v14, 12288, v14
  v_add_u32 v15, 0x10000, v14
  v_lshlrev_b32 v12, 4, v5
  v_add_u32 v12, 2048, v12
  v_lshlrev_b32 v13, 1, v10
  s_mov_b32 s54, 16384
  s_waitcnt vmcnt(0) lgkmcnt(0)
  s_mul_i32 s50, s51, 0x9E3779B1
  s_add_u32 s50, s50, 0x7F4A7C15
  v_mov_b32 v1, 28
  v_mov_b32 v2, 1
  s_mov_b64 exec, 1
  ds_add_u32 v1, v2
  s_mov_b64 exec, -1
L_sb_1:
  s_sub_u32 s68, s68, 1
  s_cbranch_scc1 L_fail
  ds_read_b32 v2, v1
  s_waitcnt lgkmcnt(0)
  v_readfirstlane_b32 s52, v2
  s_nop 0
  s_cmp_lt_u32 s52, 4
  s_cbranch_scc1 L_sb_1
  ds_read_b64_tr_b16 v[64:65], v14 offset:0
  ds_read_b64_tr_b16 v[66:67], v14 offset:512
  ds_read_b64_tr_b16 v[68:69], v14 offset:4096
  ds_read_b64_tr_b16 v[70:71], v14 offset:4608
  ds_read_b64_tr_b16 v[72:73], v14 offset:8192
  ds_read_b64_tr_b16 v[74:75], v14 offset:8704
  ds_read_b64_tr_b16 v[76:77], v14 offset:12288
  ds_read_b64_tr_b16 v[78:79], v14 offset:12800
  s_waitcnt lgkmcnt(6)
  ds_read_b64_tr_b16 v[80:81], v14 offset:16384
  ds_read_b64_tr_b16 v[82:83], v14 offset:16896
  ds_read_b64_tr_b16 v[84:85], v14 offset:20480
  ds_read_b64_tr_b16 v[86:87], v14 offset:20992
  ds_read_b64_tr_b16 v[88:89], v14 offset:24576
  ds_read_b64_tr_b16 v[90:91], v14 offset:25088
  ds_read_b64_tr_b16 v[92:93], v14 offset:28672
  ds_read_b64_tr_b16 v[94:95], v14 offset:29184
  s_waitcnt lgkmcnt(6)
  ds_read_b64_tr_b16 v[96:97], v14 offset:32768
  ds_read_b64_tr_b16 v[98:99], v14 offset:33280
  ds_read_b64_tr_b16 v[100:101], v14 offset:36864
  ds_read_b64_tr_b16 v[102:103], v14 offset:37376
  ds_read_b64_tr_b16 v[104:105], v14 offset:40960
  ds_read_b64_tr_b16 v[106:107], v14 offset:41472
  ds_read_b64_tr_b16 v[108:109], v14 offset:45056
  ds_read_b64_tr_b16 v[110:111], v14 offset:45568
  s_waitcnt lgkmcnt(6)
  ds_read_b64_tr_b16 v[112:113], v14 offset:49152
  ds_read_b64_tr_b16 v[114:115], v14 offset:49664
  ds_read_b64_tr_b16 v[116:117], v14 offset:53248
  ds_read_b64_tr_b16 v[118:119], v14 offset:53760
  ds_read_b64_tr_b16 v[120:121], v14 offset:57344
  ds_read_b64_tr_b16 v[122:123], v14 offset:57856
  ds_read_b64_tr_b16 v[124:125], v14 offset:61440
  ds_read_b64_tr_b16 v[126:127], v14 offset:61952
  s_waitcnt lgkmcnt(6)
  ds_read_b64_tr_b16 v[128:129], v15 offset:0
  ds_read_b64_tr_b16 v[130:131], v15 offset:512
  ds_read_b64_tr_b16 v[132:133], v15 offset:4096
  ds_read_b64_tr_b16 v[134:135], v15 offset:4608
  ds_read_b64_tr_b16 v[136:137], v15 offset:8192
  ds_read_b64_tr_b16 v[138:139], v15 offset:8704
  ds_read_b64_tr_b16 v[140:141], v15 offset:12288
  ds_read_b64_tr_b16 v[142:143], v15 offset:12800
  s_waitcnt lgkmcnt(0)
  s_cmp_eq_u32 s62, 2
  s_cbranch_scc0 L_pg
L_mp:
  s_sub_u32 s68, s68, 1
  s_cbranch_scc1 L_fail
  buffer_load_dwordx4 v[16:19], v13, s[32:35], s54 offen sc1
  buffer_load_dwordx4 v[20:23], v13, s[32:35], s54 offen offset:2560 sc1
  s_waitcnt vmcnt(0)
  v_xor_b32 v24, s50, v18
  v_bitop3_b32 v24, v24, v22, s50 bitop3:0xf6
  v_cmp_ne_u32 vcc, 0, v24
  s_cbranch_vccnz L_mp
  v_lshlrev_b32 v22, 16, v21
  v_and_b32 v23, 0xffff0000, v21
  v_lshlrev_b32 v24, 16, v20
  v_and_b32 v21, 0xffff0000, v20
  v_add_f32 v20, 1.0, v24
  v_add_f32 v21, 1.0, v21
  v_add_f32 v22, 1.0, v22
  v_add_f32 v23, 1.0, v23
  v_lshlrev_b32 v24, 16, v16
  v_and_b32 v25, 0xffff0000, v16
  v_lshlrev_b32 v26, 16, v17
  v_and_b32 v27, 0xffff0000, v17
  v_cvt_pk_bf16_f32 v21, v20, v21
  v_lshlrev_b32 v20, 16, v21
  v_and_b32 v21, 0xffff0000, v21
  v_cvt_pk_bf16_f32 v23, v22, v23
  v_lshlrev_b32 v22, 16, v23
  v_and_b32 v23, 0xffff0000, v23
  v_pk_mul_f32 v[20:21], v[28:29], v[20:21]
  v_pk_mul_f32 v[22:23], v[30:31], v[22:23]
  v_cvt_pk_bf16_f32 v21, v20, v21
  v_lshlrev_b32 v20, 16, v21
  v_and_b32 v21, 0xffff0000, v21
  v_cvt_pk_bf16_f32 v23, v22, v23
  v_lshlrev_b32 v22, 16, v23
  v_and_b32 v23, 0xffff0000, v23
  v_pk_add_f32 v[20:21], v[20:21], v[24:25]
  v_pk_add_f32 v[22:23], v[22:23], v[26:27]
  v_cvt_pk_bf16_f32 v20, v20, v21
  v_cvt_pk_bf16_f32 v21, v22, v23
  ds_write_b64 v10, v[20:21] offset:2048
  s_waitcnt lgkmcnt(0)
  v_mov_b32 v1, 64
  v_mov_b32 v2, 1
  s_mov_b64 exec, 1
  ds_add_u32 v1, v2
  s_mov_b64 exec, -1
L_sb_2:
  s_sub_u32 s68, s68, 1
  s_cbranch_scc1 L_fail
  ds_read_b32 v2, v1
  s_waitcnt lgkmcnt(0)
  v_readfirstlane_b32 s52, v2
  s_nop 0
  s_cmp_lt_u32 s52, 4
  s_cbranch_scc1 L_sb_2
L_pg:
  ds_read_b128 v[32:35], v12 offset:0
  ds_read_b128 v[36:39], v12 offset:64
  ds_read_b128 v[40:43], v12 offset:128
  ds_read_b128 v[44:47], v12 offset:192
  ds_read_b128 v[48:51], v12 offset:256
  ds_read_b128 v[52:55], v12 offset:320
  ds_read_b128 v[56:59], v12 offset:384
  s_waitcnt lgkmcnt(6)
  v_mfma_f32_16x16x32_bf16 v[16:19], v[64:67], v[32:35], 0
  ds_read_b128 v[32:35], v12 offset:448
  s_waitcnt lgkmcnt(6)
  v_mfma_f32_16x16x32_bf16 v[16:19], v[68:71], v[36:39], v[16:19]
  ds_read_b128 v[36:39], v12 offset:512
  s_waitcnt lgkmcnt(6)
  v_mfma_f32_16x16x32_bf16 v[16:19], v[72:75], v[40:43], v[16:19]
  ds_read_b128 v[40:43], v12 offset:576
  s_waitcnt lgkmcnt(6)
  v_mfma_f32_16x16x32_bf16 v[16:19], v[76:79], v[44:47], v[16:19]
  ds_read_b128 v[44:47], v12 offset:640
  s_waitcnt lgkmcnt(6)
  v_mfma_f32_16x16x32_bf16 v[16:19], v[80:83], v[48:51], v[16:19]
  ds_read_b128 v[48:51], v12 offset:704
  s_waitcnt lgkmcnt(6)
  v_mfma_f32_16x16x32_bf16 v[16:19], v[84:87], v[52:55], v[16:19]
  ds_read_b128 v[52:55], v12 offset:768
  s_waitcnt lgkmcnt(6)
  v_mfma_f32_16x16x32_bf16 v[16:19], v[88:91], v[56:59], v[16:19]
  ds_read_b128 v[56:59], v12 offset:832
  s_waitcnt lgkmcnt(6)
  v_mfma_f32_16x16x32_bf16 v[16:19], v[92:95], v[32:35], v[16:19]
  ds_read_b128 v[32:35], v12 offset:896
  s_waitcnt lgkmcnt(6)
  v_mfma_f32_16x16x32_bf16 v[16:19], v[96:99], v[36:39], v[16:19]
  ds_read_b128 v[36:39], v12 offset:960
  s_waitcnt lgkmcnt(6)
  v_mfma_f32_16x16x32_bf16 v[16:19], v[100:103], v[40:43], v[16:19]
  ds_read_b128 v[40:43], v12 offset:1024
  s_waitcnt lgkmcnt(6)
  v_mfma_f32_16x16x32_bf16 v[16:19], v[104:107], v[44:47], v[16:19]
  ds_read_b128 v[44:47], v12 offset:1088
  s_waitcnt lgkmcnt(6)
  v_mfma_f32_16x16x32_bf16 v[16:19], v[108:111], v[48:51], v[16:19]
  ds_read_b128 v[48:51], v12 offset:1152
  s_waitcnt lgkmcnt(6)
  v_mfma_f32_16x16x32_bf16 v[16:19], v[112:115], v[52:55], v[16:19]
  ds_read_b128 v[52:55], v12 offset:1216
  s_waitcnt lgkmcnt(6)
  v_mfma_f32_16x16x32_bf16 v[16:19], v[116:119], v[56:59], v[16:19]
  s_waitcnt lgkmcnt(5)
  v_mfma_f32_16x16x32_bf16 v[16:19], v[120:123], v[32:35], v[16:19]
  s_waitcnt lgkmcnt(4)
  v_mfma_f32_16x16x32_bf16 v[16:19], v[124:127], v[36:39], v[16:19]
  s_waitcnt lgkmcnt(3)
  v_mfma_f32_16x16x32_bf16 v[16:19], v[128:131], v[40:43], v[16:19]
  s_waitcnt lgkmcnt(2)
  v_mfma_f32_16x16x32_bf16 v[16:19], v[132:135], v[44:47], v[16:19]
  s_waitcnt lgkmcnt(1)
  v_mfma_f32_16x16x32_bf16 v[16:19], v[136:139], v[48:51], v[16:19]
  s_waitcnt lgkmcnt(0)
  v_mfma_f32_16x16x32_bf16 v[16:19], v[140:143], v[52:55], v[16:19]
  v_lshlrev_b32 v10, 4, v5
  v_mov_b32 v22, s50
  v_mov_b32 v23, s50
  s_nop 4
  v_cvt_pk_bf16_f32 v20, v16, v17
  v_cvt_pk_bf16_f32 v21, v18, v19
  s_mov_b32 exec_lo, 0x00010001
  s_mov_b32 exec_hi, 0x00010001
  buffer_store_dwordx4 v[20:23], v10, s[32:35], s59 offen sc1
  s_mov_b64 exec, -1
  v_mov_b32 v47, s58
  v_mov_b32 v46, 1
  ds_write_b32 v47, v46 offset:48
L_qp:
  s_cmp_lg_u32 s3, 0
  s_cbranch_scc1 L_mid
  v_min_u32 v15, 47, v0
  v_lshlrev_b32 v11, 3, v15
  v_lshlrev_b32 v15, 4, v15
  s_mul_i32 s56, s48, 768
  s_add_u32 s56, s56, 32768
  buffer_load_dwordx4 v[144:147], v15, s[32:35], s56 offen sc1
  s_sleep 12
  buffer_load_dwordx4 v[148:151], v15, s[32:35], s56 offen sc1
  s_sleep 12
  buffer_load_dwordx4 v[152:155], v15, s[32:35], s56 offen sc1
L_ppq:
  s_waitcnt vmcnt(2)
  v_cmp_ne_u32 vcc, s50, v146
  s_cbranch_vccz L_ppq_0
  s_sub_u32 s68, s68, 1
  s_cbranch_scc1 L_fail
  buffer_load_dwordx4 v[144:147], v15, s[32:35], s56 offen sc1
  s_waitcnt vmcnt(2)
  v_cmp_ne_u32 vcc, s50, v150
  s_cbranch_vccz L_ppq_1
  buffer_load_dwordx4 v[148:151], v15, s[32:35], s56 offen sc1
  s_waitcnt vmcnt(2)
  v_cmp_ne_u32 vcc, s50, v154
  s_cbranch_vccz L_ppq_2
  buffer_load_dwordx4 v[152:155], v15, s[32:35], s56 offen sc1
  s_branch L_ppq
L_ppq_0:
  v_min_u32 v16, -2, v144
  v_min_u32 v17, -2, v145
  s_branch L_ppq_x
L_ppq_1:
  v_min_u32 v16, -2, v148
  v_min_u32 v17, -2, v149
  s_branch L_ppq_x
L_ppq_2:
  v_min_u32 v16, -2, v152
  v_min_u32 v17, -2, v153
L_ppq_x:
  ds_write_b64 v11, v[16:17] offset:1152
L_mid:
  s_setprio 0
  s_waitcnt vmcnt(0)
  s_mov_b32 s69, 0
  s_mov_b32 s39, 0x20000
  s_cmp_ge_u32 s49, 6
  s_cbranch_scc1 L_rclr
  s_cmp_ge_u32 s49, 3
  s_cbranch_scc1 L_rs345
  s_lshl_b32 s53, s49, 1
  s_sub_u32 s52, s48, s53
  s_and_b32 s52, s52, 31
  s_cmp_eq_u32 s49, 2
  s_cselect_b32 s54, 20, 30
  s_sub_u32 s72, s52, s54
  s_add_u32 s72, s72, s53
  s_cmp_ge_u32 s52, s54
  s_cbranch_scc1 L_r5
  s_mul_i32 s70, s52, 205
  s_lshr_b32 s70, s70, 11
  s_mul_i32 s54, s70, 10
  s_sub_u32 s71, s52, s54
  s_mul_i32 s54, s49, 3
  s_add_u32 s70, s70, s54
  s_branch L_r2
L_rs345:
  s_cmp_eq_u32 s49, 5
  s_cbranch_scc1 L_rs5
  s_sub_u32 s53, s49, 3
  s_mul_i32 s72, s53, 24
  s_add_u32 s72, s72, s48
  s_cmp_lt_u32 s48, 24
  s_cbranch_scc1 L_r3
  s_lshl_b32 s53, s53, 3
  s_add_u32 s72, s48, s53
  s_sub_u32 s72, s72, 8
  s_branch L_r5
L_rs5:
  s_sub_u32 s72, s48, 20
  s_cmp_lt_u32 s72, 10
  s_cbranch_scc1 L_r4
  s_add_u32 s72, s48, 2
  s_and_b32 s72, s72, 31
  s_cmp_lt_u32 s72, 8
  s_cbranch_scc0 L_mid_done
  s_add_u32 s72, s72, 32
  s_branch L_r5
L_rclr:
  s_lshl_b32 s52, s49, 5
  s_add_u32 s52, s52, s48
  s_cmp_lg_u32 s3, 1
  s_cbranch_scc1 L_mid_done
  v_mov_b32 v12, -1
  v_mov_b32 v13, -1
  v_mov_b32 v14, -1
  v_mov_b32 v15, -1
  v_lshlrev_b32 v10, 4, v0
  s_sub_u32 s53, s52, 192
  s_lshl_b32 s52, s53, 10
  s_add_u32 s52, s52, 802816
  s_branch L_clr1
L_clr:
  buffer_store_dwordx4 v[12:15], v10, s[32:35], s52 offen sc1
  s_add_u32 s52, s52, 65536
L_clr1:
  s_cmp_lt_u32 s52, 829440
  s_cbranch_scc1 L_clr
  v_mov_b32 v11, s50
  v_mov_b32 v10, 0
  s_lshl_b32 s52, s53, 2
  s_add_u32 s52, s52, 256
  s_waitcnt vmcnt(0)
  s_mov_b64 exec, 1
  buffer_store_dword v11, v10, s[32:35], s52 offen sc1
  s_mov_b64 exec, -1
  s_branch L_mid_done
L_r2:
  s_mov_b32 s69, 2
  s_mov_b32 s36, s12
  s_mov_b32 s37, s13
  s_mov_b32 s38, 7864320
  s_mov_b32 s73, 1280
  s_mul_i32 s74, s70, 983040
  s_lshl_b32 s52, s71, 7
  s_add_u32 s74, s74, s52
  s_mov_b32 s75, 24
  s_branch L_stage
L_r3:
  s_mov_b32 s69, 3
  s_cmp_ge_u32 s72, 24
  s_cselect_b32 s36, s18, s16
  s_cselect_b32 s37, s19, s17
  s_cselect_b32 s52, 24, 0
  s_mov_b32 s38, 1966080
  s_mov_b32 s73, 3072
  s_sub_u32 s52, s72, s52
  s_lshl_b32 s74, s52, 7
  s_mov_b32 s75, 20
  s_branch L_stage
L_r4:
  s_mov_b32 s69, 4
  s_mov_b32 s36, s20
  s_mov_b32 s37, s21
  s_mov_b32 s38, 1966080
  s_mov_b32 s73, 1280
  s_lshl_b32 s74, s72, 7
  s_mov_b32 s75, 24
  s_branch L_stage
L_r5:
  s_mov_b32 s69, 5
  s_mov_b32 s36, s24
  s_mov_b32 s37, s25
  s_mov_b32 s38, 4915200
  s_mov_b32 s73, 7680
  s_lshl_b32 s74, s72, 7
  s_add_u32 s74, s74, 2560
  s_mov_b32 s75, 20
L_stage:
  v_mul_lo_u32 v9, s73, v3
  v_lshl_add_u32 v9, v4, 4, v9
  s_lshl_b32 s53, s73, 3
  s_mul_i32 s52, s53, s3
  s_add_u32 s74, s74, s52
  s_lshl_b32 s53, s73, 5
  s_lshl_b32 s54, s3, 5
  v_add_u32 v10, s54, v7
  v_add_u32 v10, 12288, v10
  v_add_u32 v11, 0x10000, v10
  v_mov_b32 v1, 32
L_freew:
  s_sub_u32 s68, s68, 1
  s_cbranch_scc1 L_fail
  s_sleep 4
  ds_read_b128 v[16:19], v1
  s_waitcnt lgkmcnt(0)
  v_and_b32 v16, v16, v17
  v_and_b32 v18, v18, v19
  v_and_b32 v16, v16, v18
  v_cmp_eq_u32 vcc, 0, v16
  s_cbranch_vccnz L_freew
  s_cmp_lg_u32 s69, 5
  s_cbranch_scc1 L_nosilu
  s_mov_b32 s44, s22
  s_mov_b32 s45, s23
  s_mov_b32 s46, 1280
  s_mov_b32 s47, 0x20000
  v_mov_b32 v21, v10
  s_mul_i32 s52, s3, 320
  v_lshlrev_b32 v10, 3, v0
  buffer_load_dwordx2 v[12:13], v10, s[44:47], s52 offen
  v_add_u32 v10, s52, v10
  s_waitcnt vmcnt(0)
  v_lshlrev_b32 v14, 16, v12
  v_and_b32 v15, 0xffff0000, v12
  v_lshlrev_b32 v16, 16, v13
  v_and_b32 v17, 0xffff0000, v13
  v_mul_f32 v18, 0xbfb8aa3b, v14
  v_exp_f32 v18, v18
  s_nop 0
  v_add_f32 v18, 1.0, v18
  v_rcp_f32 v19, v18
  s_nop 0
  v_mul_f32 v20, v14, v19
  v_fma_f32 v18, -v20, v18, v14
  v_fma_f32 v14, v18, v19, v20
  v_cmp_class_f32 vcc, v14, 3
  s_nop 1
  v_cndmask_b32 v14, v14, v20, vcc
  v_mul_f32 v18, 0xbfb8aa3b, v15
  v_exp_f32 v18, v18
  s_nop 0
  v_add_f32 v18, 1.0, v18
  v_rcp_f32 v19, v18
  s_nop 0
  v_mul_f32 v20, v15, v19
  v_fma_f32 v18, -v20, v18, v15
  v_fma_f32 v15, v18, v19, v20
  v_cmp_class_f32 vcc, v15, 3
  s_nop 1
  v_cndmask_b32 v15, v15, v20, vcc
  v_mul_f32 v18, 0xbfb8aa3b, v16
  v_exp_f32 v18, v18
  s_nop 0
  v_add_f32 v18, 1.0, v18
  v_rcp_f32 v19, v18
  s_nop 0
  v_mul_f32 v20, v16, v19
  v_fma_f32 v18, -v20, v18, v16
  v_fma_f32 v16, v18, v19, v20
  v_cmp_class_f32 vcc, v16, 3
  s_nop 1
  v_cndmask_b32 v16, v16, v20, vcc
  v_mul_f32 v18, 0xbfb8aa3b, v17
  v_exp_f32 v18, v18
  s_nop 0
  v_add_f32 v18, 1.0, v18
  v_rcp_f32 v19, v18
  s_nop 0
  v_mul_f32 v20, v17, v19
  v_fma_f32 v18, -v20, v18, v17
  v_fma_f32 v17, v18, v19, v20
  v_cmp_class_f32 vcc, v17, 3
  s_nop 1
  v_cndmask_b32 v17, v17, v20, vcc
  v_cvt_pk_bf16_f32 v12, v14, v15
  v_cvt_pk_bf16_f32 v13, v16, v17
  s_mov_b32 exec_hi, 0xff
  ds_write_b64 v10, v[12:13] offset:2048
  s_mov_b64 exec, -1
  v_mov_b32 v10, v21
L_nosilu:
  s_lshl_b32 s52, s3, 10
  s_add_u32 m0, s52, 12288
  s_mov_b32 s55, s75
L_dma_3:
  buffer_load_dwordx4 v9, s[36:39], s74 offen nt lds
  s_add_u32 m0, m0, 4096
  s_add_u32 s74, s74, s53
  s_sub_u32 s55, s55, 1
  s_cmp_lg_u32 s55, 0
  s_cbranch_scc1 L_dma_3
  s_waitcnt vmcnt(0) lgkmcnt(0)
  v_mov_b32 v1, 16
  v_mov_b32 v2, 1
  s_mov_b64 exec, 1
  ds_add_u32 v1, v2
  s_mov_b64 exec, -1
L_sb_4:
  s_sub_u32 s68, s68, 1
  s_cbranch_scc1 L_fail
  ds_read_b32 v2, v1
  s_waitcnt lgkmcnt(0)
  v_readfirstlane_b32 s52, v2
  s_nop 0
  s_cmp_lt_u32 s52, 4
  s_cbranch_scc1 L_sb_4
  ds_read_b64_tr_b16 v[64:65], v10 offset:0
  ds_read_b64_tr_b16 v[66:67], v10 offset:512
  ds_read_b64_tr_b16 v[68:69], v10 offset:4096
  ds_read_b64_tr_b16 v[70:71], v10 offset:4608
  ds_read_b64_tr_b16 v[72:73], v10 offset:8192
  ds_read_b64_tr_b16 v[74:75], v10 offset:8704
  ds_read_b64_tr_b16 v[76:77], v10 offset:12288
  ds_read_b64_tr_b16 v[78:79], v10 offset:12800
  s_waitcnt lgkmcnt(6)
  ds_read_b64_tr_b16 v[80:81], v10 offset:16384
  ds_read_b64_tr_b16 v[82:83], v10 offset:16896
  ds_read_b64_tr_b16 v[84:85], v10 offset:20480
  ds_read_b64_tr_b16 v[86:87], v10 offset:20992
  ds_read_b64_tr_b16 v[88:89], v10 offset:24576
  ds_read_b64_tr_b16 v[90:91], v10 offset:25088
  ds_read_b64_tr_b16 v[92:93], v10 offset:28672
  ds_read_b64_tr_b16 v[94:95], v10 offset:29184
  s_waitcnt lgkmcnt(6)
  ds_read_b64_tr_b16 v[96:97], v10 offset:32768
  ds_read_b64_tr_b16 v[98:99], v10 offset:33280
  ds_read_b64_tr_b16 v[100:101], v10 offset:36864
  ds_read_b64_tr_b16 v[102:103], v10 offset:37376
  ds_read_b64_tr_b16 v[104:105], v10 offset:40960
  ds_read_b64_tr_b16 v[106:107], v10 offset:41472
  ds_read_b64_tr_b16 v[108:109], v10 offset:45056
  ds_read_b64_tr_b16 v[110:111], v10 offset:45568
  s_waitcnt lgkmcnt(6)
  ds_read_b64_tr_b16 v[112:113], v10 offset:49152
  ds_read_b64_tr_b16 v[114:115], v10 offset:49664
  ds_read_b64_tr_b16 v[116:117], v10 offset:53248
  ds_read_b64_tr_b16 v[118:119], v10 offset:53760
  ds_read_b64_tr_b16 v[120:121], v10 offset:57344
  ds_read_b64_tr_b16 v[122:123], v10 offset:57856
  ds_read_b64_tr_b16 v[124:125], v10 offset:61440
  ds_read_b64_tr_b16 v[126:127], v10 offset:61952
  s_waitcnt lgkmcnt(6)
  ds_read_b64_tr_b16 v[128:129], v11 offset:0
  ds_read_b64_tr_b16 v[130:131], v11 offset:512
  ds_read_b64_tr_b16 v[132:133], v11 offset:4096
  ds_read_b64_tr_b16 v[134:135], v11 offset:4608
  ds_read_b64_tr_b16 v[136:137], v11 offset:8192
  ds_read_b64_tr_b16 v[138:139], v11 offset:8704
  ds_read_b64_tr_b16 v[140:141], v11 offset:12288
  ds_read_b64_tr_b16 v[142:143], v11 offset:12800
  s_waitcnt lgkmcnt(6)
  ds_read_b64_tr_b16 v[144:145], v11 offset:16384
  ds_read_b64_tr_b16 v[146:147], v11 offset:16896
  ds_read_b64_tr_b16 v[148:149], v11 offset:20480
  ds_read_b64_tr_b16 v[150:151], v11 offset:20992
  ds_read_b64_tr_b16 v[152:153], v11 offset:24576
  ds_read_b64_tr_b16 v[154:155], v11 offset:25088
  ds_read_b64_tr_b16 v[156:157], v11 offset:28672
  ds_read_b64_tr_b16 v[158:159], v11 offset:29184
  s_waitcnt lgkmcnt(0)
  s_cmp_lg_u32 s69, 4
  s_cbranch_scc1 L_staged
  v_mov_b32 v1, 20
  v_mov_b32 v2, 1
  s_mov_b64 exec, 1
  ds_add_u32 v1, v2
  s_mov_b64 exec, -1
L_sb_5:
  s_sub_u32 s68, s68, 1
  s_cbranch_scc1 L_fail
  ds_read_b32 v2, v1
  s_waitcnt lgkmcnt(0)
  v_readfirstlane_b32 s52, v2
  s_nop 0
  s_cmp_lt_u32 s52, 4
  s_cbranch_scc1 L_sb_5
  s_lshl_b32 s52, s3, 10
  s_add_u32 m0, s52, 12288
  s_mov_b32 s55, s75
L_dma_6:
  buffer_load_dwordx4 v9, s[36:39], s74 offen nt lds
  s_add_u32 m0, m0, 4096
  s_add_u32 s74, s74, s53
  s_sub_u32 s55, s55, 1
  s_cmp_lg_u32 s55, 0
  s_cbranch_scc1 L_dma_6
  s_waitcnt vmcnt(0) lgkmcnt(0)
  v_mov_b32 v1, 24
  v_mov_b32 v2, 1
  s_mov_b64 exec, 1
  ds_add_u32 v1, v2
  s_mov_b64 exec, -1
L_sb_7:
  s_sub_u32 s68, s68, 1
  s_cbranch_scc1 L_fail
  ds_read_b32 v2, v1
  s_waitcnt lgkmcnt(0)
  v_readfirstlane_b32 s52, v2
  s_nop 0
  s_cmp_lt_u32 s52, 4
  s_cbranch_scc1 L_sb_7
  ds_read_b64_tr_b16 v[160:161], v10 offset:0
  ds_read_b64_tr_b16 v[162:163], v10 offset:512
  ds_read_b64_tr_b16 v[164:165], v10 offset:4096
  ds_read_b64_tr_b16 v[166:167], v10 offset:4608
  ds_read_b64_tr_b16 v[168:169], v10 offset:8192
  ds_read_b64_tr_b16 v[170:171], v10 offset:8704
  ds_read_b64_tr_b16 v[172:173], v10 offset:12288
  ds_read_b64_tr_b16 v[174:175], v10 offset:12800
  s_waitcnt lgkmcnt(6)
  ds_read_b64_tr_b16 v[176:177], v10 offset:16384
  ds_read_b64_tr_b16 v[178:179], v10 offset:16896
  ds_read_b64_tr_b16 v[180:181], v10 offset:20480
  ds_read_b64_tr_b16 v[182:183], v10 offset:20992
  ds_read_b64_tr_b16 v[184:185], v10 offset:24576
  ds_read_b64_tr_b16 v[186:187], v10 offset:25088
  ds_read_b64_tr_b16 v[188:189], v10 offset:28672
  ds_read_b64_tr_b16 v[190:191], v10 offset:29184
  s_waitcnt lgkmcnt(6)
  ds_read_b64_tr_b16 v[192:193], v10 offset:32768
  ds_read_b64_tr_b16 v[194:195], v10 offset:33280
  ds_read_b64_tr_b16 v[196:197], v10 offset:36864
  ds_read_b64_tr_b16 v[198:199], v10 offset:37376
  ds_read_b64_tr_b16 v[200:201], v10 offset:40960
  ds_read_b64_tr_b16 v[202:203], v10 offset:41472
  ds_read_b64_tr_b16 v[204:205], v10 offset:45056
  ds_read_b64_tr_b16 v[206:207], v10 offset:45568
  s_waitcnt lgkmcnt(6)
  ds_read_b64_tr_b16 v[208:209], v10 offset:49152
  ds_read_b64_tr_b16 v[210:211], v10 offset:49664
  ds_read_b64_tr_b16 v[212:213], v10 offset:53248
  ds_read_b64_tr_b16 v[214:215], v10 offset:53760
  ds_read_b64_tr_b16 v[216:217], v10 offset:57344
  ds_read_b64_tr_b16 v[218:219], v10 offset:57856
  ds_read_b64_tr_b16 v[220:221], v10 offset:61440
  ds_read_b64_tr_b16 v[222:223], v10 offset:61952
  s_waitcnt lgkmcnt(6)
  ds_read_b64_tr_b16 v[224:225], v11 offset:0
  ds_read_b64_tr_b16 v[226:227], v11 offset:512
  ds_read_b64_tr_b16 v[228:229], v11 offset:4096
  ds_read_b64_tr_b16 v[230:231], v11 offset:4608
  ds_read_b64_tr_b16 v[232:233], v11 offset:8192
  ds_read_b64_tr_b16 v[234:235], v11 offset:8704
  ds_read_b64_tr_b16 v[236:237], v11 offset:12288
  ds_read_b64_tr_b16 v[238:239], v11 offset:12800
  s_waitcnt lgkmcnt(6)
  ds_read_b64_tr_b16 v[240:241], v11 offset:16384
  ds_read_b64_tr_b16 v[242:243], v11 offset:16896
  ds_read_b64_tr_b16 v[244:245], v11 offset:20480
  ds_read_b64_tr_b16 v[246:247], v11 offset:20992
  ds_read_b64_tr_b16 v[248:249], v11 offset:24576
  ds_read_b64_tr_b16 v[250:251], v11 offset:25088
  ds_read_b64_tr_b16 v[252:253], v11 offset:28672
  ds_read_b64_tr_b16 v[254:255], v11 offset:29184
  s_waitcnt lgkmcnt(0)
L_staged:
  v_lshlrev_b32 v12, 4, v5
  v_add_u32 v12, 2048, v12
  s_cmp_lg_u32 s69, 5
  s_cbranch_scc1 L_not5
  ds_read_b128 v[32:35], v12 offset:0
  ds_read_b128 v[36:39], v12 offset:64
  ds_read_b128 v[40:43], v12 offset:128
  ds_read_b128 v[44:47], v12 offset:192
  ds_read_b128 v[48:51], v12 offset:256
  ds_read_b128 v[52:55], v12 offset:320
  ds_read_b128 v[56:59], v12 offset:384
  s_waitcnt lgkmcnt(6)
  v_mfma_f32_16x16x32_bf16 v[16:19], v[64:67], v[32:35], 0
  ds_read_b128 v[32:35], v12 offset:448
  s_waitcnt lgkmcnt(6)
  v_mfma_f32_16x16x32_bf16 v[16:19], v[68:71], v[36:39], v[16:19]
  ds_read_b128 v[36:39], v12 offset:512
  s_waitcnt lgkmcnt(6)
  v_mfma_f32_16x16x32_bf16 v[16:19], v[72:75], v[40:43], v[16:19]
  ds_read_b128 v[40:43], v12 offset:576
  s_waitcnt lgkmcnt(6)
  v_mfma_f32_16x16x32_bf16 v[16:19], v[76:79], v[44:47], v[16:19]
  ds_read_b128 v[44:47], v12 offset:640
  s_waitcnt lgkmcnt(6)
  v_mfma_f32_16x16x32_bf16 v[16:19], v[80:83], v[48:51], v[16:19]
  ds_read_b128 v[48:51], v12 offset:704
  s_waitcnt lgkmcnt(6)
  v_mfma_f32_16x16x32_bf16 v[16:19], v[84:87], v[52:55], v[16:19]
  ds_read_b128 v[52:55], v12 offset:768
  s_waitcnt lgkmcnt(6)
  v_mfma_f32_16x16x32_bf16 v[16:19], v[88:91], v[56:59], v[16:19]
  ds_read_b128 v[56:59], v12 offset:832
  s_waitcnt lgkmcnt(6)
  v_mfma_f32_16x16x32_bf16 v[16:19], v[92:95], v[32:35], v[16:19]
  ds_read_b128 v[32:35], v12 offset:896
  s_waitcnt lgkmcnt(6)
  v_mfma_f32_16x16x32_bf16 v[16:19], v[96:99], v[36:39], v[16:19]
  ds_read_b128 v[36:39], v12 offset:960
  s_waitcnt lgkmcnt(6)
  v_mfma_f32_16x16x32_bf16 v[16:19], v[100:103], v[40:43], v[16:19]
  ds_read_b128 v[40:43], v12 offset:1024
  s_waitcnt lgkmcnt(6)
  v_mfma_f32_16x16x32_bf16 v[16:19], v[104:107], v[44:47], v[16:19]
  ds_read_b128 v[44:47], v12 offset:1088
  s_waitcnt lgkmcnt(6)
  v_mfma_f32_16x16x32_bf16 v[16:19], v[108:111], v[48:51], v[16:19]
  ds_read_b128 v[48:51], v12 offset:1152
  s_waitcnt lgkmcnt(6)
  v_mfma_f32_16x16x32_bf16 v[16:19], v[112:115], v[52:55], v[16:19]
  ds_read_b128 v[52:55], v12 offset:1216
  s_waitcnt lgkmcnt(6)
  v_mfma_f32_16x16x32_bf16 v[16:19], v[116:119], v[56:59], v[16:19]
  s_waitcnt lgkmcnt(5)
  v_mfma_f32_16x16x32_bf16 v[16:19], v[120:123], v[32:35], v[16:19]
  s_waitcnt lgkmcnt(4)
  v_mfma_f32_16x16x32_bf16 v[16:19], v[124:127], v[36:39], v[16:19]
  s_waitcnt lgkmcnt(3)
  v_mfma_f32_16x16x32_bf16 v[16:19], v[128:131], v[40:43], v[16:19]
  s_waitcnt lgkmcnt(2)
  v_mfma_f32_16x16x32_bf16 v[16:19], v[132:135], v[44:47], v[16:19]
  s_waitcnt lgkmcnt(1)
  v_mfma_f32_16x16x32_bf16 v[16:19], v[136:139], v[48:51], v[16:19]
  s_waitcnt lgkmcnt(0)
  v_mfma_f32_16x16x32_bf16 v[16:19], v[140:143], v[52:55], v[16:19]
  s_lshl_b32 s52, s72, 8
  s_lshl_b32 s53, s3, 6
  s_add_u32 s52, s52, s53
  s_add_u32 s52, s52, 21504
  v_lshlrev_b32 v10, 4, v5
  v_mov_b32 v22, s50
  v_mov_b32 v23, s50
  s_nop 0
  v_cvt_pk_bf16_f32 v20, v16, v17
  v_cvt_pk_bf16_f32 v21, v18, v19
  s_mov_b32 exec_lo, 0x00010001
  s_mov_b32 exec_hi, 0x00010001
  buffer_store_dwordx4 v[20:23], v10, s[32:35], s52 offen sc1
  s_mov_b64 exec, -1
  s_branch L_mid_done
L_not5:
  v_lshlrev_b32 v10, 2, v0
  s_mov_b32 s52, 256
L_clrwait:
  s_sub_u32 s68, s68, 1
  s_cbranch_scc1 L_fail
  s_sleep 8
  buffer_load_dword v13, v10, s[32:35], s52 offen sc1
  s_waitcnt vmcnt(0)
  v_cmp_ne_u32 vcc, s50, v13
  s_cbranch_vccnz L_clrwait
  s_cmp_eq_u32 s69, 2
  s_cbranch_scc1 L_mid_done
  s_mov_b32 s40, s4
  s_mov_b32 s41, s5
  s_mov_b32 s42, 1280
  s_mov_b32 s43, 0x20000
  s_cmp_eq_u32 s69, 4
  s_cbranch_scc1 L_m4
  s_mul_i32 s52, s3, 640
  v_min_u32 v13, 39, v0
  v_lshlrev_b32 v13, 4, v13
  v_add_u32 v13, s52, v13
  s_mov_b32 s53, 24064
  s_mov_b32 s54, 26624
  s_branch L_m34
L_m4:
  s_lshl_b32 s52, s72, 8
  s_lshl_b32 s53, s3, 6
  s_add_u32 s52, s52, s53
  v_lshlrev_b32 v13, 4, v5
  v_add_u32 v13, s52, v13
  s_mov_b32 s53, 29184
  s_mov_b32 s54, 29184
L_m34:
  v_lshrrev_b32 v14, 1, v13
  s_mov_b32 s52, 21504
  buffer_load_dwordx2 v[28:29], v14, s[40:43], 0 offen
L_mbpoll:
  s_sub_u32 s68, s68, 1
  s_cbranch_scc1 L_fail
  s_sleep 8
  buffer_load_dwordx4 v[16:19], v13, s[32:35], s52 offen sc1
  buffer_load_dwordx4 v[20:23], v13, s[32:35], s53 offen sc1
  buffer_load_dwordx4 v[24:27], v13, s[32:35], s54 offen sc1
  v_mov_b32 v15, 0
  s_waitcnt vmcnt(0)
  v_bitop3_b32 v15, v15, v18, s50 bitop3:0xf6
  v_bitop3_b32 v15, v15, v22, s50 bitop3:0xf6
  v_bitop3_b32 v15, v15, v26, s50 bitop3:0xf6
  v_cmp_ne_u32 vcc, 0, v15
  s_cbranch_vccnz L_mbpoll
  v_lshlrev_b32 v44, 16, v28
  v_and_b32 v45, 0xffff0000, v28
  v_lshlrev_b32 v46, 16, v29
  v_and_b32 v47, 0xffff0000, v29
  v_lshlrev_b32 v48, 16, v16
  v_and_b32 v49, 0xffff0000, v16
  v_lshlrev_b32 v50, 16, v17
  v_and_b32 v51, 0xffff0000, v17
  v_lshlrev_b32 v52, 16, v20
  v_and_b32 v53, 0xffff0000, v20
  v_lshlrev_b32 v54, 16, v21
  v_and_b32 v55, 0xffff0000, v21
  v_lshlrev_b32 v56, 16, v24
  v_and_b32 v57, 0xffff0000, v24
  v_lshlrev_b32 v58, 16, v25
  v_and_b32 v59, 0xffff0000, v25
  v_add_f32 v56, 1.0, v56
  v_add_f32 v57, 1.0, v57
  v_add_f32 v58, 1.0, v58
  v_add_f32 v59, 1.0, v59
  v_cvt_pk_bf16_f32 v57, v56, v57
  v_lshlrev_b32 v56, 16, v57
  v_and_b32 v57, 0xffff0000, v57
  v_cvt_pk_bf16_f32 v59, v58, v59
  v_lshlrev_b32 v58, 16, v59
  v_and_b32 v59, 0xffff0000, v59
L_mid_done:
  s_mov_b64 s[4:5], 0
  s_mov_b64 s[6:7], 0
  s_mov_b64 s[8:9], 0
  s_mov_b64 s[10:11], 0
  s_mov_b64 s[12:13], 0
  s_mov_b32 s14, 1
  s_mov_b64 exec, 0
  s_branch L_b5
L_dry_done:
  s_setprio 0
  s_mov_b64 exec, -1
  s_mov_b64 s[4:5], -1
  s_mov_b32 s6, 0x00010001
  s_mov_b32 s7, 0x00010001
  s_mov_b32 s8, -1
  s_mov_b32 s9, 0xff
  s_mov_b32 s10, 0
  s_mov_b32 s11, 0x80000000
  s_mov_b64 s[12:13], 1
  s_mov_b32 s14, 0
  s_cmp_lg_u32 s3, 0
  s_cbranch_scc1 L_b5
  s_lshl_b32 s52, s48, 8
  s_add_u32 s52, s52, 4096
  s_add_u32 s60, s30, s52
  s_addc_u32 s61, s31, 0
  s_mov_b32 s76, 336
  s_mov_b32 s77, -1
  s_mov_b32 s63, 0
  v_mov_b32 v10, 0
L_grab:
  s_sub_u32 s68, s68, 1
  s_cbranch_scc1 L_fail
  s_sleep 2
  ds_read_b128 v[16:19], v10 offset:0
  s_waitcnt lgkmcnt(0)
  v_min3_u32 v16, v16, v17, v18
  v_min_u32 v16, v16, v19
  s_nop 0
  v_readfirstlane_b32 s52, v16
  s_nop 0
  s_add_u32 s52, s52, s63
  s_cmp_lt_u32 s52, s76
  s_cbranch_scc1 L_grab
  s_cmp_lg_u32 s77, -1
  s_cbranch_scc1 L_grab1
  s_load_dword s77, s[60:61], 0 glc
  s_waitcnt lgkmcnt(0)
L_grab1:
  s_min_u32 s52, s77, 96
  s_sub_u32 s52, 96, s52
  s_lshr_b32 s52, s52, 3
  s_max_u32 s78, s52, 1
  s_mov_b32 s79, s78
  s_atomic_add s79, s[60:61], 0 glc
  s_waitcnt lgkmcnt(0)
  s_min_u32 s53, s79, 96
  s_sub_u32 s52, 96, s53
  s_min_u32 s52, s52, s78
  s_mul_i32 s54, s48, 5
  s_add_u32 s54, s54, s53
  s_lshl_b32 s54, s54, 2
  s_add_u32 s54, s54, 1664
  v_lshlrev_b32 v16, 2, v0
  v_add_u32 v17, s54, v16
  v_and_b32 v17, 2047, v17
  v_add_u32 v16, s76, v16
  s_add_u32 s55, s53, s78
  s_cmp_ge_u32 s55, 96
  s_cselect_b32 s56, 1, 0
  v_mov_b32 v18, 2147483647
  v_cmp_gt_u32 vcc, s52, v0
  s_nop 1
  v_cndmask_b32 v17, v18, v17, vcc
  s_add_u32 s57, s52, s56
  v_cmp_gt_u32 vcc, s57, v0
  s_nop 0
  s_and_saveexec_b64 s[58:59], vcc
  ds_write_b32 v16, v17
  s_mov_b64 exec, -1
  s_lshl_b32 s52, s52, 2
  s_add_u32 s76, s76, s52
  s_mul_i32 s52, s78, 8
  s_add_u32 s77, s79, s52
  s_cmp_ge_u32 s77, 1073741824
  s_cselect_b32 s63, -4, s63
  s_cmp_eq_u32 s56, 0
  s_cbranch_scc1 L_grab
  s_waitcnt lgkmcnt(0)
L_b5:
  s_setprio 3
  s_cmp_lg_u32 s14, 0
  s_cbranch_scc1 L_nb1
  s_barrier
L_nb1:
  s_cmp_lg_u32 s3, 0
  s_cbranch_scc1 L_t1_done
  v_lshlrev_b32 v10, 2, v0
  v_add_u32 v10, 5120, v10
  v_mov_b32 v11, 11264
  ds_read_b128 v[16:19], v11
  ds_read_b128 v[20:23], v11 offset:16
  ds_read2st64_b32 v[24:25], v10 offset0:0 offset1:1
  ds_read2st64_b32 v[26:27], v10 offset0:2 offset1:3
  ds_read2st64_b32 v[28:29], v10 offset0:4 offset1:5
  ds_read2st64_b32 v[30:31], v10 offset0:6 offset1:7
  ds_read2st64_b32 v[32:33], v10 offset0:8 offset1:9
  ds_read2st64_b32 v[34:35], v10 offset0:10 offset1:11
  ds_read2st64_b32 v[36:37], v10 offset0:12 offset1:13
  ds_read2st64_b32 v[38:39], v10 offset0:14 offset1:15
  ds_read2st64_b32 v[40:41], v10 offset0:16 offset1:17
  ds_read2st64_b32 v[42:43], v10 offset0:18 offset1:19
  ds_read2st64_b32 v[14:15], v10 offset0:20 offset1:21
  ds_read2st64_b32 v[60:61], v10 offset0:22 offset1:23
  s_lshl_b32 s52, s2, 10
  s_add_u32 s52, s52, 524288
  s_lshl_b32 s53, s2, 4
  s_add_u32 s53, s53, 786432
  v_lshlrev_b32 v11, 4, v0
  s_waitcnt lgkmcnt(12)
  v_min3_f32 v8, v16, v18, v20
  v_min_f32 v8, v8, v22
  v_sub_f32 v16, v8, v16
  v_sub_f32 v18, v8, v18
  v_sub_f32 v20, v8, v20
  v_sub_f32 v22, v8, v22
  v_exp_f32 v16, v16
  v_exp_f32 v18, v18
  v_exp_f32 v20, v20
  v_exp_f32 v22, v22
  v_mul_f32 v9, v16, v17
  v_fmac_f32 v9, v18, v19
  v_fmac_f32 v9, v20, v21
  v_fmac_f32 v9, v22, v23
  s_waitcnt lgkmcnt(0)
  v_add_f32 v24, v24, v27
  v_add_f32 v25, v25, v28
  v_add_f32 v26, v26, v29
  v_add_f32 v30, v30, v33
  v_add_f32 v31, v31, v34
  v_add_f32 v32, v32, v35
  v_add_f32 v36, v36, v39
  v_add_f32 v37, v37, v40
  v_add_f32 v38, v38, v41
  v_add_f32 v42, v42, v15
  v_add_f32 v43, v43, v60
  v_add_f32 v14, v14, v61
  v_mul_f32 v17, v16, v24
  v_mul_f32 v19, v16, v25
  v_mul_f32 v21, v16, v26
  v_fmac_f32 v17, v18, v30
  v_fmac_f32 v19, v18, v31
  v_fmac_f32 v21, v18, v32
  v_fmac_f32 v17, v20, v36
  v_fmac_f32 v19, v20, v37
  v_fmac_f32 v21, v20, v38
  v_fmac_f32 v17, v22, v42
  v_fmac_f32 v19, v22, v43
  v_fmac_f32 v21, v22, v14
  v_mov_b32 v24, v17
  v_mov_b32 v25, v19
  v_mov_b32 v26, v21
  v_mov_b32 v27, s50
  v_mov_b32 v28, v8
  v_mov_b32 v29, v9
  v_mov_b32 v30, s50
  v_mov_b32 v31, s50
  buffer_store_dwordx4 v[24:27], v11, s[32:35], s52 offen sc1
  s_mov_b64 exec, s[12:13]
  buffer_store_dwordx4 v[28:31], v11, s[32:35], s53 offen sc1
  s_mov_b64 exec, s[4:5]
L_t1_done:
  s_cmp_eq_u32 s69, 3
  s_cbranch_scc1 L_t3
  s_cmp_eq_u32 s69, 4
  s_cbranch_scc1 L_t4
  s_cmp_eq_u32 s69, 2
  s_cbranch_scc0 L_hend
  s_lshl_b32 s52, s70, 2
  s_add_u32 s52, s52, s3
  s_lshl_b32 s53, s52, 13
  s_add_u32 s53, s53, 524288
  s_lshl_b32 s54, s52, 7
  s_add_u32 s54, s54, 786432
  v_lshlrev_b32 v10, 4, v0
  v_lshlrev_b32 v11, 4, v4
  s_add_u32 s55, s53, 4096
L_t2gate:
  s_sub_u32 s68, s68, 1
  s_cbranch_scc1 L_fail
  buffer_load_dwordx4 v[48:51], v11, s[32:35], s54 offen sc1
  s_waitcnt vmcnt(0)
  v_cmp_ne_u32 s[78:79], s50, v50
  s_nop 0
  s_and_b32 s56, s78, 0xff
  s_bcnt1_i32_b32 s56, s56
  s_cmp_gt_u32 s56, 2
  s_cbranch_scc1 L_t2gate
  s_mov_b64 s[80:81], s[4:5]
  s_mov_b64 s[82:83], s[4:5]
  s_mov_b64 s[84:85], s[4:5]
  s_mov_b64 s[86:87], s[4:5]
  s_mov_b64 s[88:89], s[4:5]
  s_mov_b64 s[90:91], s[4:5]
  s_mov_b64 s[92:93], s[4:5]
  s_mov_b64 s[94:95], s[4:5]
L_t2poll:
  s_sub_u32 s68, s68, 1
  s_cbranch_scc1 L_fail
  buffer_load_dwordx4 v[48:51], v11, s[32:35], s54 offen sc1
  buffer_load_dwordx4 v[16:19], v10, s[32:35], s53 offen offset:0 sc1
  buffer_load_dwordx4 v[20:23], v10, s[32:35], s53 offen offset:1024 sc1
  buffer_load_dwordx4 v[24:27], v10, s[32:35], s53 offen offset:2048 sc1
  buffer_load_dwordx4 v[28:31], v10, s[32:35], s53 offen offset:3072 sc1
  buffer_load_dwordx4 v[32:35], v10, s[32:35], s55 offen offset:0 sc1
  buffer_load_dwordx4 v[36:39], v10, s[32:35], s55 offen offset:1024 sc1
  buffer_load_dwordx4 v[40:43], v10, s[32:35], s55 offen offset:2048 sc1
  buffer_load_dwordx4 v[44:47], v10, s[32:35], s55 offen offset:3072 sc1
  s_waitcnt vmcnt(8)
  v_xor_b32 v14, s50, v50
  s_waitcnt vmcnt(7)
  v_bitop3_b32 v14, v14, v19, s50 bitop3:0xf6
  s_waitcnt vmcnt(6)
  v_bitop3_b32 v14, v14, v23, s50 bitop3:0xf6
  s_waitcnt vmcnt(5)
  v_bitop3_b32 v14, v14, v27, s50 bitop3:0xf6
  s_waitcnt vmcnt(4)
  v_bitop3_b32 v14, v14, v31, s50 bitop3:0xf6
  s_waitcnt vmcnt(3)
  v_bitop3_b32 v14, v14, v35, s50 bitop3:0xf6
  s_waitcnt vmcnt(2)
  v_bitop3_b32 v14, v14, v39, s50 bitop3:0xf6
  s_waitcnt vmcnt(1)
  v_bitop3_b32 v14, v14, v43, s50 bitop3:0xf6
  s_waitcnt vmcnt(0)
  v_bitop3_b32 v14, v14, v47, s50 bitop3:0xf6
  v_cmp_ne_u32 vcc, 0, v14
  s_cbranch_vccnz L_t2poll
  v_min_f32_dpp v52, v48, v48 row_ror:4 row_mask:0xf bank_mask:0xf
  s_nop 1
  v_min_f32_dpp v52, v52, v52 row_ror:2 row_mask:0xf bank_mask:0xf
  s_nop 1
  v_min_f32_dpp v52, v52, v52 row_ror:1 row_mask:0xf bank_mask:0xf
  v_sub_f32 v52, v52, v48
  v_exp_f32 v52, v52
  s_nop 0
  v_mul_f32 v53, v52, v49
  s_nop 1
  v_add_f32_dpp v53, v53, v53 row_ror:4 row_mask:0xf bank_mask:0xf
  s_nop 1
  v_add_f32_dpp v53, v53, v53 row_ror:2 row_mask:0xf bank_mask:0xf
  s_nop 1
  v_add_f32_dpp v53, v53, v53 row_ror:1 row_mask:0xf bank_mask:0xf
  v_rcp_f32 v53, v53
  s_nop 0
  v_mul_f32 v52, v52, v53
  s_nop 0
  v_readlane_b32 s80, v52, 0
  v_readlane_b32 s81, v52, 1
  v_readlane_b32 s82, v52, 2
  v_readlane_b32 s83, v52, 3
  v_readlane_b32 s84, v52, 4
  v_readlane_b32 s85, v52, 5
  v_readlane_b32 s86, v52, 6
  v_readlane_b32 s87, v52, 7
  s_mul_i32 s52, s3, 384
  v_lshl_add_u32 v11, v0, 1, s52
  v_mul_f32 v54, s80, v16
  v_mul_f32 v55, s80, v17
  v_mul_f32 v56, s80, v18
  v_fmac_f32 v54, s81, v20
  v_fmac_f32 v55, s81, v21
  v_fmac_f32 v56, s81, v22
  v_fmac_f32 v54, s82, v24
  v_fmac_f32 v55, s82, v25
  v_fmac_f32 v56, s82, v26
  v_fmac_f32 v54, s83, v28
  v_fmac_f32 v55, s83, v29
  v_fmac_f32 v56, s83, v30
  v_fmac_f32 v54, s84, v32
  v_fmac_f32 v55, s84, v33
  v_fmac_f32 v56, s84, v34
  v_fmac_f32 v54, s85, v36
  v_fmac_f32 v55, s85, v37
  v_fmac_f32 v56, s85, v38
  v_fmac_f32 v54, s86, v40
  v_fmac_f32 v55, s86, v41
  v_fmac_f32 v56, s86, v42
  v_fmac_f32 v54, s87, v44
  v_fmac_f32 v55, s87, v45
  v_fmac_f32 v56, s87, v46
  v_cvt_pk_bf16_f32 v54, v54, v55
  v_cvt_pk_bf16_f32 v56, v56, v56
  ds_write_b16 v11, v54 offset:2048
  ds_write_b16_d16_hi v11, v54 offset:2176
  ds_write_b16 v11, v56 offset:2304
  s_mul_i32 s52, s70, 2560
  s_lshl_b32 s53, s71, 8
  s_add_u32 s52, s52, s53
  s_lshl_b32 s53, s3, 6
  s_add_u32 s52, s52, s53
  s_add_u32 s52, s52, 808960
  v_lshlrev_b32 v10, 4, v5
  s_waitcnt lgkmcnt(0)
  s_cmp_lg_u32 s14, 0
  s_cbranch_scc1 L_nb2
  s_barrier
L_nb2:
  ds_read_b128 v[32:35], v12 offset:0
  ds_read_b128 v[36:39], v12 offset:64
  ds_read_b128 v[40:43], v12 offset:128
  ds_read_b128 v[44:47], v12 offset:192
  ds_read_b128 v[48:51], v12 offset:256
  ds_read_b128 v[52:55], v12 offset:320
  ds_read_b128 v[56:59], v12 offset:384
  s_waitcnt lgkmcnt(6)
  v_mfma_f32_16x16x32_bf16 v[16:19], v[64:67], v[32:35], 0
  ds_read_b128 v[32:35], v12 offset:448
  s_waitcnt lgkmcnt(6)
  v_mfma_f32_16x16x32_bf16 v[16:19], v[68:71], v[36:39], v[16:19]
  ds_read_b128 v[36:39], v12 offset:512
  s_waitcnt lgkmcnt(6)
  v_mfma_f32_16x16x32_bf16 v[16:19], v[72:75], v[40:43], v[16:19]
  ds_read_b128 v[40:43], v12 offset:576
  s_waitcnt lgkmcnt(6)
  v_mfma_f32_16x16x32_bf16 v[16:19], v[76:79], v[44:47], v[16:19]
  ds_read_b128 v[44:47], v12 offset:640
  s_waitcnt lgkmcnt(6)
  v_mfma_f32_16x16x32_bf16 v[16:19], v[80:83], v[48:51], v[16:19]
  ds_read_b128 v[48:51], v12 offset:704
  s_waitcnt lgkmcnt(6)
  v_mfma_f32_16x16x32_bf16 v[16:19], v[84:87], v[52:55], v[16:19]
  ds_read_b128 v[52:55], v12 offset:768
  s_waitcnt lgkmcnt(6)
  v_mfma_f32_16x16x32_bf16 v[16:19], v[88:91], v[56:59], v[16:19]
  ds_read_b128 v[56:59], v12 offset:832
  s_waitcnt lgkmcnt(6)
  v_mfma_f32_16x16x32_bf16 v[16:19], v[92:95], v[32:35], v[16:19]
  ds_read_b128 v[32:35], v12 offset:896
  s_waitcnt lgkmcnt(6)
  v_mfma_f32_16x16x32_bf16 v[16:19], v[96:99], v[36:39], v[16:19]
  ds_read_b128 v[36:39], v12 offset:960
  s_waitcnt lgkmcnt(6)
  v_mfma_f32_16x16x32_bf16 v[16:19], v[100:103], v[40:43], v[16:19]
  ds_read_b128 v[40:43], v12 offset:1024
  s_waitcnt lgkmcnt(6)
  v_mfma_f32_16x16x32_bf16 v[16:19], v[104:107], v[44:47], v[16:19]
  ds_read_b128 v[44:47], v12 offset:1088
  s_waitcnt lgkmcnt(6)
  v_mfma_f32_16x16x32_bf16 v[16:19], v[108:111], v[48:51], v[16:19]
  ds_read_b128 v[48:51], v12 offset:1152
  s_waitcnt lgkmcnt(6)
  v_mfma_f32_16x16x32_bf16 v[16:19], v[112:115], v[52:55], v[16:19]
  ds_read_b128 v[52:55], v12 offset:1216
  s_waitcnt lgkmcnt(6)
  v_mfma_f32_16x16x32_bf16 v[16:19], v[116:119], v[56:59], v[16:19]
  ds_read_b128 v[56:59], v12 offset:1280
  s_waitcnt lgkmcnt(6)
  v_mfma_f32_16x16x32_bf16 v[16:19], v[120:123], v[32:35], v[16:19]
  ds_read_b128 v[32:35], v12 offset:1344
  s_waitcnt lgkmcnt(6)
  v_mfma_f32_16x16x32_bf16 v[16:19], v[124:127], v[36:39], v[16:19]
  ds_read_b128 v[36:39], v12 offset:1408
  s_waitcnt lgkmcnt(6)
  v_mfma_f32_16x16x32_bf16 v[16:19], v[128:131], v[40:43], v[16:19]
  ds_read_b128 v[40:43], v12 offset:1472
  s_waitcnt lgkmcnt(6)
  v_mfma_f32_16x16x32_bf16 v[16:19], v[132:135], v[44:47], v[16:19]
  s_waitcnt lgkmcnt(5)
  v_mfma_f32_16x16x32_bf16 v[16:19], v[136:139], v[48:51], v[16:19]
  s_waitcnt lgkmcnt(4)
  v_mfma_f32_16x16x32_bf16 v[16:19], v[140:143], v[52:55], v[16:19]
  s_waitcnt lgkmcnt(3)
  v_mfma_f32_16x16x32_bf16 v[16:19], v[144:147], v[56:59], v[16:19]
  s_waitcnt lgkmcnt(2)
  v_mfma_f32_16x16x32_bf16 v[16:19], v[148:151], v[32:35], v[16:19]
  s_waitcnt lgkmcnt(1)
  v_mfma_f32_16x16x32_bf16 v[16:19], v[152:155], v[36:39], v[16:19]
  s_waitcnt lgkmcnt(0)
  v_mfma_f32_16x16x32_bf16 v[16:19], v[156:159], v[40:43], v[16:19]
  s_nop 7
  v_min_u32 v16, -2, v16
  v_min_u32 v17, -2, v17
  v_min_u32 v18, -2, v18
  v_min_u32 v19, -2, v19
  s_mov_b64 exec, s[6:7]
  buffer_store_dwordx4 v[16:19], v10, s[32:35], s52 offen sc1
  s_branch L_hend
L_t3:
  s_sub_u32 s56, s49, 3
  s_min_u32 s56, s56, 0
  s_mul_i32 s56, s56, 20480
  s_add_u32 s52, s56, 808960
  s_add_u32 s53, s56, 814080
  s_add_u32 s54, s56, 819200
  s_add_u32 s55, s56, 824320
  s_mov_b64 s[80:81], s[4:5]
  s_mov_b64 s[82:83], s[4:5]
  s_mov_b64 s[84:85], s[4:5]
  s_mov_b64 s[86:87], s[4:5]
  s_mov_b64 s[88:89], s[4:5]
  s_mov_b64 s[90:91], s[4:5]
  s_mov_b64 s[92:93], s[4:5]
  s_mov_b64 s[94:95], s[4:5]
  s_and_b32 s56, s72, 3
  s_mul_i32 s56, s56, 2560
  s_add_u32 s56, s56, s52
  s_add_u32 s57, s56, 10240
L_gate3:
  s_sub_u32 s68, s68, 1
  s_cbranch_scc1 L_fail
  s_sleep 4
  buffer_load_dword v14, v13, s[32:35], s56 offen sc1
  buffer_load_dword v15, v13, s[32:35], s57 offen sc1
  s_waitcnt vmcnt(0)
  v_cmp_eq_u32 s[58:59], -1, v14
  v_cmp_eq_u32 vcc, -1, v15
  s_cmp_eq_u64 s[58:59], 0
  s_cbranch_scc1 L_ap3
  s_cbranch_vccnz L_gate3
L_ap3:
  s_sub_u32 s68, s68, 1
  s_cbranch_scc1 L_fail
  buffer_load_dwordx4 v[16:19], v13, s[32:35], s52 offen offset:0 sc1
  buffer_load_dwordx4 v[20:23], v13, s[32:35], s52 offen offset:2560 sc1
  buffer_load_dwordx4 v[24:27], v13, s[32:35], s53 offen offset:0 sc1
  buffer_load_dwordx4 v[28:31], v13, s[32:35], s53 offen offset:2560 sc1
  buffer_load_dwordx4 v[32:35], v13, s[32:35], s54 offen offset:0 sc1
  buffer_load_dwordx4 v[36:39], v13, s[32:35], s54 offen offset:2560 sc1
  buffer_load_dwordx4 v[40:43], v13, s[32:35], s55 offen offset:0 sc1
  buffer_load_dwordx4 v[8:11], v13, s[32:35], s55 offen offset:2560 sc1
  s_waitcnt vmcnt(5)
  v_max3_u32 v14, v16, v20, v24
  s_waitcnt vmcnt(3)
  v_max3_u32 v14, v14, v28, v32
  s_waitcnt vmcnt(1)
  v_max3_u32 v14, v14, v36, v40
  s_waitcnt vmcnt(0)
  v_max_u32 v14, v14, v8
  v_cmp_eq_u32 vcc, -1, v14
  s_cbranch_vccnz L_ap3
  v_pk_add_f32 v[16:17], v[16:17], v[20:21]
  v_pk_add_f32 v[18:19], v[18:19], v[22:23]
  v_pk_add_f32 v[24:25], v[24:25], v[28:29]
  v_pk_add_f32 v[26:27], v[26:27], v[30:31]
  v_pk_add_f32 v[32:33], v[32:33], v[36:37]
  v_pk_add_f32 v[34:35], v[34:35], v[38:39]
  v_pk_add_f32 v[40:41], v[40:41], v[8:9]
  v_pk_add_f32 v[42:43], v[42:43], v[10:11]
  v_pk_add_f32 v[16:17], v[16:17], v[24:25]
  v_pk_add_f32 v[18:19], v[18:19], v[26:27]
  v_pk_add_f32 v[32:33], v[32:33], v[40:41]
  v_pk_add_f32 v[34:35], v[34:35], v[42:43]
  v_pk_add_f32 v[16:17], v[16:17], v[32:33]
  v_pk_add_f32 v[18:19], v[18:19], v[34:35]
  v_pk_fma_f32 v[16:17], v[48:49], v[16:17], v[44:45]
  v_pk_fma_f32 v[18:19], v[50:51], v[18:19], v[46:47]
  v_readfirstlane_b32 s58, v16
  v_cmp_gt_u32 vcc, 40, v0
  v_mov_b32 v26, 0
  v_subrev_f32 v20, s58, v16
  v_subrev_f32 v21, s58, v17
  v_subrev_f32 v22, s58, v18
  v_subrev_f32 v23, s58, v19
  v_add_f32 v24, v20, v21
  v_mul_f32 v25, v20, v20
  v_add_f32 v24, v24, v22
  v_fmac_f32 v25, v21, v21
  v_add_f32 v24, v24, v23
  v_fmac_f32 v25, v22, v22
  v_fmac_f32 v25, v23, v23
  v_cndmask_b32 v24, v26, v24, vcc
  v_cndmask_b32 v25, v26, v25, vcc
  s_nop 0
  v_add_f32_dpp v24, v24, v24 row_ror:8 row_mask:0xf bank_mask:0xf
  v_add_f32_dpp v25, v25, v25 row_ror:8 row_mask:0xf bank_mask:0xf
  s_nop 0
  v_add_f32_dpp v24, v24, v24 row_ror:4 row_mask:0xf bank_mask:0xf
  v_add_f32_dpp v25, v25, v25 row_ror:4 row_mask:0xf bank_mask:0xf
  s_nop 0
  v_add_f32_dpp v24, v24, v24 row_ror:2 row_mask:0xf bank_mask:0xf
  v_add_f32_dpp v25, v25, v25 row_ror:2 row_mask:0xf bank_mask:0xf
  s_nop 0
  v_add_f32_dpp v24, v24, v24 row_ror:1 row_mask:0xf bank_mask:0xf
  v_add_f32_dpp v25, v25, v25 row_ror:1 row_mask:0xf bank_mask:0xf
  s_nop 0
  v_add_f32_dpp v24, v24, v24 row_bcast:15 row_mask:0xa bank_mask:0xf
  v_add_f32_dpp v25, v25, v25 row_bcast:15 row_mask:0xa bank_mask:0xf
  s_nop 0
  v_add_f32_dpp v24, v24, v24 row_bcast:31 row_mask:0xc bank_mask:0xf
  v_add_f32_dpp v25, v25, v25 row_bcast:31 row_mask:0xc bank_mask:0xf
  v_mul_f32 v26, 0x3bcccccd, v24
  v_fma_f32 v25, -v26, v24, v25
  v_add_f32 v24, s58, v26
  s_lshl_b32 s52, s3, 3
  v_mov_b32 v27, s52
  s_mov_b64 exec, s[10:11]
  ds_write_b64 v27, v[24:25] offset:11328
  s_mov_b64 exec, s[4:5]
  v_mov_b32 v27, 11328
  s_waitcnt lgkmcnt(0)
  s_cmp_lg_u32 s14, 0
  s_cbranch_scc1 L_nb3
  s_barrier
L_nb3:
  ds_read_b128 v[28:31], v27
  ds_read_b128 v[32:35], v27 offset:16
  v_lshrrev_b32 v14, 1, v13
  s_waitcnt lgkmcnt(0)
  v_add_f32 v24, v28, v30
  v_add_f32 v25, v32, v34
  v_add_f32 v24, v24, v25
  v_mul_f32 v24, 0x3e800000, v24
  v_add_f32 v25, v29, v31
  v_add_f32 v26, v33, v35
  v_add_f32 v25, v25, v26
  v_sub_f32 v28, v28, v24
  v_sub_f32 v30, v30, v24
  v_sub_f32 v32, v32, v24
  v_sub_f32 v34, v34, v24
  v_mul_f32 v26, v28, v28
  v_fmac_f32 v26, v30, v30
  v_fmac_f32 v26, v32, v32
  v_fmac_f32 v26, v34, v34
  v_mul_f32 v25, 0x3acccccd, v25
  v_fmac_f32 v25, 0x3e800000, v26
  v_add_f32 v25, 0x3727c5ac, v25
  v_rsq_f32 v26, v25
  v_sub_f32 v16, v16, v24
  v_sub_f32 v17, v17, v24
  v_sub_f32 v18, v18, v24
  v_sub_f32 v19, v19, v24
  v_mov_b32 v27, v26
  v_pk_mul_f32 v[20:21], v[56:57], v[26:27]
  v_pk_mul_f32 v[22:23], v[58:59], v[26:27]
  v_pk_fma_f32 v[20:21], v[16:17], v[20:21], v[52:53]
  v_pk_fma_f32 v[22:23], v[18:19], v[22:23], v[54:55]
  v_cvt_pk_bf16_f32 v20, v20, v21
  v_cvt_pk_bf16_f32 v21, v22, v23
  s_mov_b64 exec, s[8:9]
  ds_write_b64 v14, v[20:21] offset:2048
  s_mov_b64 exec, s[4:5]
  s_lshl_b32 s52, s72, 7
  s_lshl_b32 s53, s3, 5
  s_add_u32 s52, s52, s53
  s_add_u32 s52, s52, 802816
  v_lshlrev_b32 v10, 3, v5
  v_and_b32 v8, 3, v0
  v_cmp_eq_u32 s[58:59], 1, v8
  v_cmp_eq_u32 s[60:61], 2, v8
  v_cmp_eq_u32 s[62:63], 3, v8
  s_waitcnt lgkmcnt(0)
  s_cmp_lg_u32 s14, 0
  s_cbranch_scc1 L_nb4
  s_barrier
L_nb4:
  ds_read_b128 v[32:35], v12 offset:0
  ds_read_b128 v[36:39], v12 offset:64
  ds_read_b128 v[40:43], v12 offset:128
  ds_read_b128 v[44:47], v12 offset:192
  ds_read_b128 v[48:51], v12 offset:256
  ds_read_b128 v[52:55], v12 offset:320
  ds_read_b128 v[56:59], v12 offset:384
  s_waitcnt lgkmcnt(6)
  v_mfma_f32_16x16x32_bf16 v[16:19], v[64:67], v[32:35], 0
  ds_read_b128 v[32:35], v12 offset:448
  s_waitcnt lgkmcnt(6)
  v_mfma_f32_16x16x32_bf16 v[16:19], v[68:71], v[36:39], v[16:19]
  ds_read_b128 v[36:39], v12 offset:512
  s_waitcnt lgkmcnt(6)
  v_mfma_f32_16x16x32_bf16 v[16:19], v[72:75], v[40:43], v[16:19]
  ds_read_b128 v[40:43], v12 offset:576
  s_waitcnt lgkmcnt(6)
  v_mfma_f32_16x16x32_bf16 v[16:19], v[76:79], v[44:47], v[16:19]
  ds_read_b128 v[44:47], v12 offset:640
  s_waitcnt lgkmcnt(6)
  v_mfma_f32_16x16x32_bf16 v[16:19], v[80:83], v[48:51], v[16:19]
  ds_read_b128 v[48:51], v12 offset:704
  s_waitcnt lgkmcnt(6)
  v_mfma_f32_16x16x32_bf16 v[16:19], v[84:87], v[52:55], v[16:19]
  ds_read_b128 v[52:55], v12 offset:768
  s_waitcnt lgkmcnt(6)
  v_mfma_f32_16x16x32_bf16 v[16:19], v[88:91], v[56:59], v[16:19]
  ds_read_b128 v[56:59], v12 offset:832
  s_waitcnt lgkmcnt(6)
  v_mfma_f32_16x16x32_bf16 v[16:19], v[92:95], v[32:35], v[16:19]
  ds_read_b128 v[32:35], v12 offset:896
  s_waitcnt lgkmcnt(6)
  v_mfma_f32_16x16x32_bf16 v[16:19], v[96:99], v[36:39], v[16:19]
  ds_read_b128 v[36:39], v12 offset:960
  s_waitcnt lgkmcnt(6)
  v_mfma_f32_16x16x32_bf16 v[16:19], v[100:103], v[40:43], v[16:19]
  ds_read_b128 v[40:43], v12 offset:1024
  s_waitcnt lgkmcnt(6)
  v_mfma_f32_16x16x32_bf16 v[16:19], v[104:107], v[44:47], v[16:19]
  ds_read_b128 v[44:47], v12 offset:1088
  s_waitcnt lgkmcnt(6)
  v_mfma_f32_16x16x32_bf16 v[16:19], v[108:111], v[48:51], v[16:19]
  ds_read_b128 v[48:51], v12 offset:1152
  s_waitcnt lgkmcnt(6)
  v_mfma_f32_16x16x32_bf16 v[16:19], v[112:115], v[52:55], v[16:19]
  ds_read_b128 v[52:55], v12 offset:1216
  s_waitcnt lgkmcnt(6)
  v_mfma_f32_16x16x32_bf16 v[16:19], v[116:119], v[56:59], v[16:19]
  s_waitcnt lgkmcnt(5)
  v_mfma_f32_16x16x32_bf16 v[16:19], v[120:123], v[32:35], v[16:19]
  s_waitcnt lgkmcnt(4)
  v_mfma_f32_16x16x32_bf16 v[16:19], v[124:127], v[36:39], v[16:19]
  s_waitcnt lgkmcnt(3)
  v_mfma_f32_16x16x32_bf16 v[16:19], v[128:131], v[40:43], v[16:19]
  s_waitcnt lgkmcnt(2)
  v_mfma_f32_16x16x32_bf16 v[16:19], v[132:135], v[44:47], v[16:19]
  s_waitcnt lgkmcnt(1)
  v_mfma_f32_16x16x32_bf16 v[16:19], v[136:139], v[48:51], v[16:19]
  s_waitcnt lgkmcnt(0)
  v_mfma_f32_16x16x32_bf16 v[16:19], v[140:143], v[52:55], v[16:19]
  s_cmp_ge_u32 s72, 24
  s_cbranch_scc1 L_t3up
  s_nop 5
  v_cndmask_b32 v16, v16, v17, s[58:59]
  v_cndmask_b32 v16, v16, v18, s[60:61]
  v_cndmask_b32 v16, v16, v19, s[62:63]
  v_mul_f32 v17, v16, v16
  v_mov_b32 v18, 0xc0135761
  v_fmac_f32 v18, 0xbdd2d3e8, v17
  v_mul_f32 v17, v16, v18
  v_exp_f32 v17, v17
  s_nop 0
  v_add_f32 v17, 1.0, v17
  v_rcp_f32 v17, v17
  s_nop 0
  v_mul_f32 v16, v16, v17
  s_nop 1
  v_mov_b32_dpp v17, v16 quad_perm:[1,1,1,1] row_mask:0xf bank_mask:0xf
  v_mov_b32_dpp v18, v16 quad_perm:[2,2,2,2] row_mask:0xf bank_mask:0xf
  v_mov_b32_dpp v19, v16 quad_perm:[3,3,3,3] row_mask:0xf bank_mask:0xf
L_t3up:
  s_nop 5
  v_cvt_pk_bf16_f32 v16, v16, v17
  v_cvt_pk_bf16_f32 v17, v18, v19
  v_min_u32 v16, -2, v16
  v_min_u32 v17, -2, v17
  s_mov_b64 exec, s[6:7]
  buffer_store_dwordx2 v[16:17], v10, s[32:35], s52 offen sc1
  s_branch L_hend
L_t4:
  s_sub_u32 s56, s49, 3
  s_min_u32 s56, s56, 0
  s_mul_i32 s56, s56, 20480
  s_add_u32 s52, s56, 808960
  s_add_u32 s53, s56, 814080
  s_add_u32 s54, s56, 819200
  s_add_u32 s55, s56, 824320
  s_mov_b64 s[80:81], s[4:5]
  s_mov_b64 s[82:83], s[4:5]
  s_mov_b64 s[84:85], s[4:5]
  s_mov_b64 s[86:87], s[4:5]
  s_mov_b64 s[88:89], s[4:5]
  s_mov_b64 s[90:91], s[4:5]
  s_mov_b64 s[92:93], s[4:5]
  s_mov_b64 s[94:95], s[4:5]
  s_and_b32 s56, s72, 3
  s_mul_i32 s56, s56, 2560
  s_add_u32 s56, s56, s52
  s_add_u32 s57, s56, 10240
L_gate4:
  s_sub_u32 s68, s68, 1
  s_cbranch_scc1 L_fail
  s_sleep 4
  buffer_load_dword v14, v13, s[32:35], s56 offen sc1
  buffer_load_dword v15, v13, s[32:35], s57 offen sc1
  s_waitcnt vmcnt(0)
  v_cmp_eq_u32 s[58:59], -1, v14
  v_cmp_eq_u32 vcc, -1, v15
  s_cmp_eq_u64 s[58:59], 0
  s_cbranch_scc1 L_ap4
  s_cbranch_vccnz L_gate4
L_ap4:
  s_sub_u32 s68, s68, 1
  s_cbranch_scc1 L_fail
  buffer_load_dwordx4 v[16:19], v13, s[32:35], s52 offen offset:0 sc1
  buffer_load_dwordx4 v[20:23], v13, s[32:35], s52 offen offset:2560 sc1
  buffer_load_dwordx4 v[24:27], v13, s[32:35], s53 offen offset:0 sc1
  buffer_load_dwordx4 v[28:31], v13, s[32:35], s53 offen offset:2560 sc1
  buffer_load_dwordx4 v[32:35], v13, s[32:35], s54 offen offset:0 sc1
  buffer_load_dwordx4 v[36:39], v13, s[32:35], s54 offen offset:2560 sc1
  buffer_load_dwordx4 v[40:43], v13, s[32:35], s55 offen offset:0 sc1
  buffer_load_dwordx4 v[8:11], v13, s[32:35], s55 offen offset:2560 sc1
  s_waitcnt vmcnt(5)
  v_max3_u32 v14, v16, v20, v24
  s_waitcnt vmcnt(3)
  v_max3_u32 v14, v14, v28, v32
  s_waitcnt vmcnt(1)
  v_max3_u32 v14, v14, v36, v40
  s_waitcnt vmcnt(0)
  v_max_u32 v14, v14, v8
  v_cmp_eq_u32 vcc, -1, v14
  s_cbranch_vccnz L_ap4
  v_pk_add_f32 v[16:17], v[16:17], v[20:21]
  v_pk_add_f32 v[18:19], v[18:19], v[22:23]
  v_pk_add_f32 v[24:25], v[24:25], v[28:29]
  v_pk_add_f32 v[26:27], v[26:27], v[30:31]
  v_pk_add_f32 v[32:33], v[32:33], v[36:37]
  v_pk_add_f32 v[34:35], v[34:35], v[38:39]
  v_pk_add_f32 v[40:41], v[40:41], v[8:9]
  v_pk_add_f32 v[42:43], v[42:43], v[10:11]
  v_pk_add_f32 v[16:17], v[16:17], v[24:25]
  v_pk_add_f32 v[18:19], v[18:19], v[26:27]
  v_pk_add_f32 v[32:33], v[32:33], v[40:41]
  v_pk_add_f32 v[34:35], v[34:35], v[42:43]
  v_pk_add_f32 v[16:17], v[16:17], v[32:33]
  v_pk_add_f32 v[18:19], v[18:19], v[34:35]
  v_pk_fma_f32 v[16:17], v[48:49], v[16:17], v[44:45]
  v_pk_fma_f32 v[18:19], v[50:51], v[18:19], v[46:47]
  v_mov_b32 v44, v16
  v_mov_b32 v45, v17
  v_mov_b32 v46, v18
  v_mov_b32 v47, v19
  s_mov_b32 s44, s26
  s_mov_b32 s45, s27
  s_mov_b32 s46, 1280
  s_mov_b32 s47, 0x20000
  s_lshl_b32 s52, s3, 10
  v_lshl_add_u32 v10, v0, 4, s52
  s_mov_b32 s53, 802816
  s_mov_b32 s54, 805888
  v_lshrrev_b32 v14, 1, v13
  s_cmp_eq_u32 s3, 3
  s_cbranch_scc1 L_t4b
L_gupoll:
  s_sub_u32 s68, s68, 1
  s_cbranch_scc1 L_fail
  buffer_load_dwordx4 v[16:19], v10, s[32:35], s53 offen sc1
  buffer_load_dwordx4 v[20:23], v10, s[32:35], s54 offen sc1
  s_waitcnt vmcnt(0)
  v_max3_u32 v24, v16, v18, v20
  v_max_u32 v24, v24, v22
  v_cmp_eq_u32 vcc, -1, v24
  s_cbranch_vccnz L_gupoll
  v_lshlrev_b32 v24, 16, v16
  v_and_b32 v25, 0xffff0000, v16
  v_lshlrev_b32 v26, 16, v20
  v_and_b32 v27, 0xffff0000, v20
  v_pk_mul_f32 v[24:25], v[24:25], v[26:27]
  v_cvt_pk_bf16_f32 v16, v24, v25
  v_lshlrev_b32 v24, 16, v17
  v_and_b32 v25, 0xffff0000, v17
  v_lshlrev_b32 v26, 16, v21
  v_and_b32 v27, 0xffff0000, v21
  v_pk_mul_f32 v[24:25], v[24:25], v[26:27]
  v_cvt_pk_bf16_f32 v17, v24, v25
  v_lshlrev_b32 v24, 16, v18
  v_and_b32 v25, 0xffff0000, v18
  v_lshlrev_b32 v26, 16, v22
  v_and_b32 v27, 0xffff0000, v22
  v_pk_mul_f32 v[24:25], v[24:25], v[26:27]
  v_cvt_pk_bf16_f32 v18, v24, v25
  v_lshlrev_b32 v24, 16, v19
  v_and_b32 v25, 0xffff0000, v19
  v_lshlrev_b32 v26, 16, v23
  v_and_b32 v27, 0xffff0000, v23
  v_pk_mul_f32 v[24:25], v[24:25], v[26:27]
  v_cvt_pk_bf16_f32 v19, v24, v25
  ds_write_b128 v10, v[16:19] offset:2048
  s_waitcnt lgkmcnt(0)
L_t4b:
  s_cmp_lg_u32 s14, 0
  s_cbranch_scc1 L_nb5
  s_barrier
L_nb5:
  ds_read_b128 v[20:23], v12 offset:0
  ds_read_b128 v[24:27], v12 offset:64
  ds_read_b128 v[28:31], v12 offset:128
  ds_read_b128 v[32:35], v12 offset:192
  ds_read_b128 v[36:39], v12 offset:256
  ds_read_b128 v[40:43], v12 offset:320
  s_waitcnt lgkmcnt(5)
  v_mfma_f32_16x16x32_bf16 v[16:19], v[64:67], v[20:23], 0
  ds_read_b128 v[20:23], v12 offset:384
  s_waitcnt lgkmcnt(5)
  v_mfma_f32_16x16x32_bf16 v[16:19], v[68:71], v[24:27], v[16:19]
  ds_read_b128 v[24:27], v12 offset:448
  s_waitcnt lgkmcnt(5)
  v_mfma_f32_16x16x32_bf16 v[16:19], v[72:75], v[28:31], v[16:19]
  ds_read_b128 v[28:31], v12 offset:512
  s_waitcnt lgkmcnt(5)
  v_mfma_f32_16x16x32_bf16 v[16:19], v[76:79], v[32:35], v[16:19]
  ds_read_b128 v[32:35], v12 offset:576
  s_waitcnt lgkmcnt(5)
  v_mfma_f32_16x16x32_bf16 v[16:19], v[80:83], v[36:39], v[16:19]
  ds_read_b128 v[36:39], v12 offset:640
  s_waitcnt lgkmcnt(5)
  v_mfma_f32_16x16x32_bf16 v[16:19], v[84:87], v[40:43], v[16:19]
  ds_read_b128 v[40:43], v12 offset:704
  s_waitcnt lgkmcnt(5)
  v_mfma_f32_16x16x32_bf16 v[16:19], v[88:91], v[20:23], v[16:19]
  ds_read_b128 v[20:23], v12 offset:768
  s_waitcnt lgkmcnt(5)
  v_mfma_f32_16x16x32_bf16 v[16:19], v[92:95], v[24:27], v[16:19]
  ds_read_b128 v[24:27], v12 offset:832
  s_waitcnt lgkmcnt(5)
  v_mfma_f32_16x16x32_bf16 v[16:19], v[96:99], v[28:31], v[16:19]
  ds_read_b128 v[28:31], v12 offset:896
  s_waitcnt lgkmcnt(5)
  v_mfma_f32_16x16x32_bf16 v[16:19], v[100:103], v[32:35], v[16:19]
  ds_read_b128 v[32:35], v12 offset:960
  s_waitcnt lgkmcnt(5)
  v_mfma_f32_16x16x32_bf16 v[16:19], v[104:107], v[36:39], v[16:19]
  ds_read_b128 v[36:39], v12 offset:1024
  s_waitcnt lgkmcnt(5)
  v_mfma_f32_16x16x32_bf16 v[16:19], v[108:111], v[40:43], v[16:19]
  ds_read_b128 v[40:43], v12 offset:1088
  s_waitcnt lgkmcnt(5)
  v_mfma_f32_16x16x32_bf16 v[16:19], v[112:115], v[20:23], v[16:19]
  ds_read_b128 v[20:23], v12 offset:1152
  s_waitcnt lgkmcnt(5)
  v_mfma_f32_16x16x32_bf16 v[16:19], v[116:119], v[24:27], v[16:19]
  ds_read_b128 v[24:27], v12 offset:1216
  s_waitcnt lgkmcnt(5)
  v_mfma_f32_16x16x32_bf16 v[16:19], v[120:123], v[28:31], v[16:19]
  ds_read_b128 v[28:31], v12 offset:1280
  s_waitcnt lgkmcnt(5)
  v_mfma_f32_16x16x32_bf16 v[16:19], v[124:127], v[32:35], v[16:19]
  ds_read_b128 v[32:35], v12 offset:1344
  s_waitcnt lgkmcnt(5)
  v_mfma_f32_16x16x32_bf16 v[16:19], v[128:131], v[36:39], v[16:19]
  ds_read_b128 v[36:39], v12 offset:1408
  s_waitcnt lgkmcnt(5)
  v_mfma_f32_16x16x32_bf16 v[16:19], v[132:135], v[40:43], v[16:19]
  ds_read_b128 v[40:43], v12 offset:1472
  s_waitcnt lgkmcnt(5)
  v_mfma_f32_16x16x32_bf16 v[16:19], v[136:139], v[20:23], v[16:19]
  ds_read_b128 v[20:23], v12 offset:1536
  s_waitcnt lgkmcnt(5)
  v_mfma_f32_16x16x32_bf16 v[16:19], v[140:143], v[24:27], v[16:19]
  ds_read_b128 v[24:27], v12 offset:1600
  s_waitcnt lgkmcnt(5)
  v_mfma_f32_16x16x32_bf16 v[16:19], v[144:147], v[28:31], v[16:19]
  ds_read_b128 v[28:31], v12 offset:1664
  s_waitcnt lgkmcnt(5)
  v_mfma_f32_16x16x32_bf16 v[16:19], v[148:151], v[32:35], v[16:19]
  ds_read_b128 v[32:35], v12 offset:1728
  s_waitcnt lgkmcnt(5)
  v_mfma_f32_16x16x32_bf16 v[16:19], v[152:155], v[36:39], v[16:19]
  ds_read_b128 v[36:39], v12 offset:1792
  s_waitcnt lgkmcnt(5)
  v_mfma_f32_16x16x32_bf16 v[16:19], v[156:159], v[40:43], v[16:19]
  ds_read_b128 v[40:43], v12 offset:1856
  s_waitcnt lgkmcnt(5)
  v_mfma_f32_16x16x32_bf16 v[16:19], v[160:163], v[20:23], v[16:19]
  ds_read_b128 v[20:23], v12 offset:1920
  s_waitcnt lgkmcnt(5)
  v_mfma_f32_16x16x32_bf16 v[16:19], v[164:167], v[24:27], v[16:19]
  ds_read_b128 v[24:27], v12 offset:1984
  s_waitcnt lgkmcnt(5)
  v_mfma_f32_16x16x32_bf16 v[16:19], v[168:171], v[28:31], v[16:19]
  ds_read_b128 v[28:31], v12 offset:2048
  s_waitcnt lgkmcnt(5)
  v_mfma_f32_16x16x32_bf16 v[16:19], v[172:175], v[32:35], v[16:19]
  ds_read_b128 v[32:35], v12 offset:2112
  s_waitcnt lgkmcnt(5)
  v_mfma_f32_16x16x32_bf16 v[16:19], v[176:179], v[36:39], v[16:19]
  ds_read_b128 v[36:39], v12 offset:2176
  s_waitcnt lgkmcnt(5)
  v_mfma_f32_16x16x32_bf16 v[16:19], v[180:183], v[40:43], v[16:19]
  ds_read_b128 v[40:43], v12 offset:2240
  s_waitcnt lgkmcnt(5)
  v_mfma_f32_16x16x32_bf16 v[16:19], v[184:187], v[20:23], v[16:19]
  ds_read_b128 v[20:23], v12 offset:2304
  s_waitcnt lgkmcnt(5)
  v_mfma_f32_16x16x32_bf16 v[16:19], v[188:191], v[24:27], v[16:19]
  ds_read_b128 v[24:27], v12 offset:2368
  s_waitcnt lgkmcnt(5)
  v_mfma_f32_16x16x32_bf16 v[16:19], v[192:195], v[28:31], v[16:19]
  ds_read_b128 v[28:31], v12 offset:2432
  s_waitcnt lgkmcnt(5)
  v_mfma_f32_16x16x32_bf16 v[16:19], v[196:199], v[32:35], v[16:19]
  ds_read_b128 v[32:35], v12 offset:2496
  s_waitcnt lgkmcnt(5)
  v_mfma_f32_16x16x32_bf16 v[16:19], v[200:203], v[36:39], v[16:19]
  ds_read_b128 v[36:39], v12 offset:2560
  s_waitcnt lgkmcnt(5)
  v_mfma_f32_16x16x32_bf16 v[16:19], v[204:207], v[40:43], v[16:19]
  ds_read_b128 v[40:43], v12 offset:2624
  s_waitcnt lgkmcnt(5)
  v_mfma_f32_16x16x32_bf16 v[16:19], v[208:211], v[20:23], v[16:19]
  ds_read_b128 v[20:23], v12 offset:2688
  s_waitcnt lgkmcnt(5)
  v_mfma_f32_16x16x32_bf16 v[16:19], v[212:215], v[24:27], v[16:19]
  ds_read_b128 v[24:27], v12 offset:2752
  s_waitcnt lgkmcnt(5)
  v_mfma_f32_16x16x32_bf16 v[16:19], v[216:219], v[28:31], v[16:19]
  ds_read_b128 v[28:31], v12 offset:2816
  s_waitcnt lgkmcnt(5)
  v_mfma_f32_16x16x32_bf16 v[16:19], v[220:223], v[32:35], v[16:19]
  ds_read_b128 v[32:35], v12 offset:2880
  s_waitcnt lgkmcnt(5)
  v_mfma_f32_16x16x32_bf16 v[16:19], v[224:227], v[36:39], v[16:19]
  ds_read_b128 v[36:39], v12 offset:2944
  s_waitcnt lgkmcnt(5)
  v_mfma_f32_16x16x32_bf16 v[16:19], v[228:231], v[40:43], v[16:19]
  ds_read_b128 v[40:43], v12 offset:3008
  s_waitcnt lgkmcnt(5)
  v_mfma_f32_16x16x32_bf16 v[16:19], v[232:235], v[20:23], v[16:19]
  s_waitcnt lgkmcnt(4)
  v_mfma_f32_16x16x32_bf16 v[16:19], v[236:239], v[24:27], v[16:19]
  s_waitcnt lgkmcnt(3)
  v_mfma_f32_16x16x32_bf16 v[16:19], v[240:243], v[28:31], v[16:19]
  s_waitcnt lgkmcnt(2)
  v_mfma_f32_16x16x32_bf16 v[16:19], v[244:247], v[32:35], v[16:19]
  s_waitcnt lgkmcnt(1)
  v_mfma_f32_16x16x32_bf16 v[16:19], v[248:251], v[36:39], v[16:19]
  s_waitcnt lgkmcnt(0)
  v_mfma_f32_16x16x32_bf16 v[16:19], v[252:255], v[40:43], v[16:19]
  s_nop 7
  v_pk_fma_f32 v[16:17], v[52:53], v[16:17], v[44:45]
  v_pk_fma_f32 v[18:19], v[54:55], v[18:19], v[46:47]
  v_cvt_pk_bf16_f32 v16, v16, v17
  v_cvt_pk_bf16_f32 v17, v18, v19
  s_mov_b64 exec, s[6:7]
  buffer_store_dwordx2 v[16:17], v14, s[44:47], 0 offen
  s_or_b32 s52, s72, s3
  s_cmp_lg_u32 s52, 0
  s_cbranch_scc1 L_hend
  s_add_u32 s52, s51, 1
  v_mov_b32 v18, s52
  v_mov_b32 v19, 0
  s_mov_b64 exec, s[12:13]
  buffer_store_dword v18, v19, s[32:35], 0 offen
L_hend:
  s_cmp_lg_u32 s14, 0
  s_cbranch_scc1 L_dry_done
  s_endpgm
L_stream:
  s_sub_u32 s52, s3, 4
  v_bfe_u32 v1, v0, 1, 3
  v_mul_u32_u24 v1, 384, v1
  v_and_b32 v2, 1, v0
  v_lshl_add_u32 v1, v2, 6, v1
  v_lshrrev_b32 v12, 4, v0
  v_lshl_add_u32 v1, v12, 4, v1
  v_add_u32 v2, 3072, v1
  v_lshrrev_b32 v3, 3, v0
  v_mul_u32_u24 v3, 384, v3
  v_and_b32 v13, 7, v0
  v_lshl_add_u32 v3, v13, 4, v3
  v_add_u32 v4, 3072, v3
  s_mul_i32 s57, s48, 12582912
  s_mul_hi_u32 s58, s48, 12582912
  s_mul_i32 s64, s48, 5
  s_add_u32 s64, s64, s49
  s_lshl_b32 s64, s64, 2
  s_add_u32 s64, s64, s52
  s_and_b32 s64, s64, 2047
  s_mul_i32 s53, s64, 6144
  s_mov_b32 s38, 12582912
  s_mov_b32 s39, 0x20000
  s_mov_b32 s42, 12582912
  s_mov_b32 s43, 0x20000
  s_waitcnt lgkmcnt(0)
  s_add_u32 s36, s6, s57
  s_addc_u32 s37, s7, s58
  s_add_u32 s40, s8, s57
  s_addc_u32 s41, s9, s58
  s_cmp_eq_u32 s62, 0
  s_cbranch_scc1 L_nob0
  s_barrier
L_nob0:
  buffer_load_dwordx4 v[56:59], v1, s[36:39], s53 offen offset:0 nt
  buffer_load_dwordx4 v[60:63], v1, s[36:39], s53 offen offset:128 nt
  buffer_load_dwordx4 v[64:67], v1, s[36:39], s53 offen offset:256 nt
  buffer_load_dwordx4 v[68:71], v2, s[36:39], s53 offen offset:0 nt
  buffer_load_dwordx4 v[72:75], v2, s[36:39], s53 offen offset:128 nt
  buffer_load_dwordx4 v[76:79], v2, s[36:39], s53 offen offset:256 nt
  buffer_load_dwordx4 v[80:83], v3, s[40:43], s53 offen offset:0 nt
  buffer_load_dwordx4 v[84:87], v3, s[40:43], s53 offen offset:128 nt
  buffer_load_dwordx4 v[88:91], v3, s[40:43], s53 offen offset:256 nt
  buffer_load_dwordx4 v[92:95], v4, s[40:43], s53 offen offset:0 nt
  buffer_load_dwordx4 v[96:99], v4, s[40:43], s53 offen offset:128 nt
  buffer_load_dwordx4 v[100:103], v4, s[40:43], s53 offen offset:256 nt
  s_cmp_lg_u32 s62, 0
  s_cbranch_scc1 L_nob1
  s_barrier
L_nob1:
  s_add_u32 s64, s64, 32
  s_and_b32 s64, s64, 2047
  s_mul_i32 s53, s64, 6144
  s_waitcnt vmcnt(10)
  buffer_load_dwordx4 v[104:107], v1, s[36:39], s53 offen offset:0 nt
  buffer_load_dwordx4 v[108:111], v1, s[36:39], s53 offen offset:128 nt
  buffer_load_dwordx4 v[112:115], v1, s[36:39], s53 offen offset:256 nt
  buffer_load_dwordx4 v[116:119], v2, s[36:39], s53 offen offset:0 nt
  buffer_load_dwordx4 v[120:123], v2, s[36:39], s53 offen offset:128 nt
  buffer_load_dwordx4 v[124:127], v2, s[36:39], s53 offen offset:256 nt
  s_waitcnt vmcnt(10)
  buffer_load_dwordx4 v[128:131], v3, s[40:43], s53 offen offset:0 nt
  buffer_load_dwordx4 v[132:135], v3, s[40:43], s53 offen offset:128 nt
  buffer_load_dwordx4 v[136:139], v3, s[40:43], s53 offen offset:256 nt
  buffer_load_dwordx4 v[140:143], v4, s[40:43], s53 offen offset:0 nt
  buffer_load_dwordx4 v[144:147], v4, s[40:43], s53 offen offset:128 nt
  buffer_load_dwordx4 v[148:151], v4, s[40:43], s53 offen offset:256 nt
  s_add_u32 s64, s64, 32
  s_and_b32 s64, s64, 2047
  s_mul_i32 s53, s64, 6144
  s_waitcnt vmcnt(10)
  buffer_load_dwordx4 v[152:155], v1, s[36:39], s53 offen offset:0 nt
  buffer_load_dwordx4 v[156:159], v1, s[36:39], s53 offen offset:128 nt
  buffer_load_dwordx4 v[160:163], v1, s[36:39], s53 offen offset:256 nt
  buffer_load_dwordx4 v[164:167], v2, s[36:39], s53 offen offset:0 nt
  buffer_load_dwordx4 v[168:171], v2, s[36:39], s53 offen offset:128 nt
  buffer_load_dwordx4 v[172:175], v2, s[36:39], s53 offen offset:256 nt
  s_waitcnt vmcnt(10)
  buffer_load_dwordx4 v[176:179], v3, s[40:43], s53 offen offset:0 nt
  buffer_load_dwordx4 v[180:183], v3, s[40:43], s53 offen offset:128 nt
  buffer_load_dwordx4 v[184:187], v3, s[40:43], s53 offen offset:256 nt
  buffer_load_dwordx4 v[188:191], v4, s[40:43], s53 offen offset:0 nt
  buffer_load_dwordx4 v[192:195], v4, s[40:43], s53 offen offset:128 nt
  buffer_load_dwordx4 v[196:199], v4, s[40:43], s53 offen offset:256 nt
  s_add_u32 s64, s64, 32
  s_and_b32 s64, s64, 2047
  s_mul_i32 s53, s64, 6144
  s_waitcnt vmcnt(10)
  buffer_load_dwordx4 v[200:203], v1, s[36:39], s53 offen offset:0 nt
  buffer_load_dwordx4 v[204:207], v1, s[36:39], s53 offen offset:128 nt
  buffer_load_dwordx4 v[208:211], v1, s[36:39], s53 offen offset:256 nt
  buffer_load_dwordx4 v[212:215], v2, s[36:39], s53 offen offset:0 nt
  buffer_load_dwordx4 v[216:219], v2, s[36:39], s53 offen offset:128 nt
  buffer_load_dwordx4 v[220:223], v2, s[36:39], s53 offen offset:256 nt
  s_waitcnt vmcnt(10)
  buffer_load_dwordx4 v[224:227], v3, s[40:43], s53 offen offset:0 nt
  buffer_load_dwordx4 v[228:231], v3, s[40:43], s53 offen offset:128 nt
  buffer_load_dwordx4 v[232:235], v3, s[40:43], s53 offen offset:256 nt
  buffer_load_dwordx4 v[236:239], v4, s[40:43], s53 offen offset:0 nt
  buffer_load_dwordx4 v[240:243], v4, s[40:43], s53 offen offset:128 nt
  buffer_load_dwordx4 v[244:247], v4, s[40:43], s53 offen offset:256 nt
  s_add_u32 s64, s64, 32
  s_and_b32 s64, s64, 2047
  s_mul_i32 s53, s64, 6144
  s_mul_i32 s59, s52, 36864
  s_add_u32 s59, s59, 12288
  s_mov_b32 s54, 156
  v_mov_b32 v17, 48
L_fw1:
  s_sub_u32 s68, s68, 1
  s_cbranch_scc1 L_fail
  s_sleep 1
  ds_read_b128 v[20:23], v17
  s_waitcnt lgkmcnt(0)
  v_and_b32 v20, v20, v21
  v_and_b32 v22, v22, v23
  v_and_b32 v20, v20, v22
  v_cmp_eq_u32 vcc, 0, v20
  s_cbranch_vccnz L_fw1
  s_waitcnt vmcnt(10)
  s_add_u32 m0, s59, 0
  s_nop 0
  buffer_load_dwordx4 v1, s[36:39], s53 offen offset:0 nt lds
  s_add_u32 m0, s59, 896
  s_nop 0
  buffer_load_dwordx4 v1, s[36:39], s53 offen offset:128 nt lds
  s_add_u32 m0, s59, 1792
  s_nop 0
  buffer_load_dwordx4 v1, s[36:39], s53 offen offset:256 nt lds
  s_add_u32 m0, s59, 3072
  s_nop 0
  buffer_load_dwordx4 v2, s[36:39], s53 offen offset:0 nt lds
  s_add_u32 m0, s59, 3968
  s_nop 0
  buffer_load_dwordx4 v2, s[36:39], s53 offen offset:128 nt lds
  s_add_u32 m0, s59, 4864
  s_nop 0
  buffer_load_dwordx4 v2, s[36:39], s53 offen offset:256 nt lds
  s_waitcnt vmcnt(10)
  s_add_u32 m0, s59, 6144
  s_nop 0
  buffer_load_dwordx4 v3, s[40:43], s53 offen offset:0 nt lds
  s_add_u32 m0, s59, 7040
  s_nop 0
  buffer_load_dwordx4 v3, s[40:43], s53 offen offset:128 nt lds
  s_add_u32 m0, s59, 7936
  s_nop 0
  buffer_load_dwordx4 v3, s[40:43], s53 offen offset:256 nt lds
  s_add_u32 m0, s59, 9216
  s_nop 0
  buffer_load_dwordx4 v4, s[40:43], s53 offen offset:0 nt lds
  s_add_u32 m0, s59, 10112
  s_nop 0
  buffer_load_dwordx4 v4, s[40:43], s53 offen offset:128 nt lds
  s_add_u32 m0, s59, 11008
  s_nop 0
  buffer_load_dwordx4 v4, s[40:43], s53 offen offset:256 nt lds
  s_add_u32 s64, s64, 32
  s_and_b32 s64, s64, 2047
  s_mul_i32 s53, s64, 6144
  s_waitcnt vmcnt(10)
  s_add_u32 m0, s59, 12288
  s_nop 0
  buffer_load_dwordx4 v1, s[36:39], s53 offen offset:0 nt lds
  s_add_u32 m0, s59, 13184
  s_nop 0
  buffer_load_dwordx4 v1, s[36:39], s53 offen offset:128 nt lds
  s_add_u32 m0, s59, 14080
  s_nop 0
  buffer_load_dwordx4 v1, s[36:39], s53 offen offset:256 nt lds
  s_add_u32 m0, s59, 15360
  s_nop 0
  buffer_load_dwordx4 v2, s[36:39], s53 offen offset:0 nt lds
  s_add_u32 m0, s59, 16256
  s_nop 0
  buffer_load_dwordx4 v2, s[36:39], s53 offen offset:128 nt lds
  s_add_u32 m0, s59, 17152
  s_nop 0
  buffer_load_dwordx4 v2, s[36:39], s53 offen offset:256 nt lds
  s_waitcnt vmcnt(10)
  s_add_u32 m0, s59, 18432
  s_nop 0
  buffer_load_dwordx4 v3, s[40:43], s53 offen offset:0 nt lds
  s_add_u32 m0, s59, 19328
  s_nop 0
  buffer_load_dwordx4 v3, s[40:43], s53 offen offset:128 nt lds
  s_add_u32 m0, s59, 20224
  s_nop 0
  buffer_load_dwordx4 v3, s[40:43], s53 offen offset:256 nt lds
  s_add_u32 m0, s59, 21504
  s_nop 0
  buffer_load_dwordx4 v4, s[40:43], s53 offen offset:0 nt lds
  s_add_u32 m0, s59, 22400
  s_nop 0
  buffer_load_dwordx4 v4, s[40:43], s53 offen offset:128 nt lds
  s_add_u32 m0, s59, 23296
  s_nop 0
  buffer_load_dwordx4 v4, s[40:43], s53 offen offset:256 nt lds
  s_add_u32 s64, s64, 32
  s_and_b32 s64, s64, 2047
  s_mul_i32 s53, s64, 6144
  s_waitcnt vmcnt(10)
  s_add_u32 m0, s59, 24576
  s_nop 0
  buffer_load_dwordx4 v1, s[36:39], s53 offen offset:0 nt lds
  s_add_u32 m0, s59, 25472
  s_nop 0
  buffer_load_dwordx4 v1, s[36:39], s53 offen offset:128 nt lds
  s_add_u32 m0, s59, 26368
  s_nop 0
  buffer_load_dwordx4 v1, s[36:39], s53 offen offset:256 nt lds
  s_add_u32 m0, s59, 27648
  s_nop 0
  buffer_load_dwordx4 v2, s[36:39], s53 offen offset:0 nt lds
  s_add_u32 m0, s59, 28544
  s_nop 0
  buffer_load_dwordx4 v2, s[36:39], s53 offen offset:128 nt lds
  s_add_u32 m0, s59, 29440
  s_nop 0
  buffer_load_dwordx4 v2, s[36:39], s53 offen offset:256 nt lds
  s_waitcnt vmcnt(10)
  s_add_u32 m0, s59, 30720
  s_nop 0
  buffer_load_dwordx4 v3, s[40:43], s53 offen offset:0 nt lds
  s_add_u32 m0, s59, 31616
  s_nop 0
  buffer_load_dwordx4 v3, s[40:43], s53 offen offset:128 nt lds
  s_add_u32 m0, s59, 32512
  s_nop 0
  buffer_load_dwordx4 v3, s[40:43], s53 offen offset:256 nt lds
  s_add_u32 m0, s59, 33792
  s_nop 0
  buffer_load_dwordx4 v4, s[40:43], s53 offen offset:0 nt lds
  s_add_u32 m0, s59, 34688
  s_nop 0
  buffer_load_dwordx4 v4, s[40:43], s53 offen offset:128 nt lds
  s_add_u32 m0, s59, 35584
  s_nop 0
  buffer_load_dwordx4 v4, s[40:43], s53 offen offset:256 nt lds
  s_add_u32 s64, s64, 32
  s_and_b32 s64, s64, 2047
  s_mul_i32 s53, s64, 6144
  v_and_b32 v14, 1, v0
  v_lshlrev_b32 v14, 4, v14
  v_mov_b32 v15, 0xffff
  v_lshlrev_b32 v14, v14, v15
  v_lshrrev_b32 v13, 1, v13
  v_mov_b32 v15, 0
  v_cmp_eq_u32 vcc, 0, v13
  s_nop 1
  v_cndmask_b32 v5, v15, v14, vcc
  v_cmp_eq_u32 vcc, 1, v13
  s_nop 1
  v_cndmask_b32 v6, v15, v14, vcc
  v_cmp_eq_u32 vcc, 2, v13
  s_nop 1
  v_cndmask_b32 v7, v15, v14, vcc
  v_cmp_eq_u32 vcc, 3, v13
  s_nop 1
  v_cndmask_b32 v8, v15, v14, vcc
  v_mov_b32 v9, 0xff800000
  v_mov_b32 v10, 0x7f800000
  v_mov_b32 v11, 0
  v_mov_b32 v28, 0
  v_mov_b32 v29, 0
  v_mov_b32 v30, 0
  v_mov_b32 v31, 0
  v_mov_b32 v32, 0
  v_mov_b32 v33, 0
  v_mov_b32 v34, 0
  v_mov_b32 v35, 0
  v_mov_b32 v36, 0
  v_mov_b32 v37, 0
  v_mov_b32 v38, 0
  v_mov_b32 v39, 0
  s_lshl_b32 s57, s52, 2
  v_mov_b32 v18, s57
  s_mov_b32 s60, 1
  s_mov_b32 s55, 0
  v_mov_b32 v17, s54
  v_bfe_u32 v13, v0, 3, 1
  v_lshlrev_b32 v13, 6, v13
  v_lshl_add_u32 v13, v12, 4, v13
  ds_read_b32 v16, v17
L_qwait:
  s_sub_u32 s68, s68, 1
  s_cbranch_scc1 L_fail
  s_sleep 1
  ds_read_b128 v[40:43], v13 offset:1152
  ds_read_b128 v[44:47], v13 offset:1280
  ds_read_b128 v[48:51], v13 offset:1408
  s_waitcnt lgkmcnt(0)
  v_max3_u32 v14, v40, v41, v42
  v_max3_u32 v15, v43, v44, v45
  v_max3_u32 v14, v14, v46, v47
  v_max3_u32 v15, v15, v48, v49
  v_max3_u32 v14, v14, v50, v51
  v_max_u32 v14, v14, v15
  v_cmp_eq_u32 vcc, -1, v14
  s_cbranch_vccnz L_qwait
L_loop:
  s_waitcnt vmcnt(12)
  v_mfma_f32_16x16x32_bf16 v[20:23], v[56:59], v[40:43], 0
  v_mfma_f32_16x16x32_bf16 v[24:27], v[68:71], v[40:43], 0
  v_mfma_f32_16x16x32_bf16 v[20:23], v[60:63], v[44:47], v[20:23]
  v_mfma_f32_16x16x32_bf16 v[24:27], v[72:75], v[44:47], v[24:27]
  v_mfma_f32_16x16x32_bf16 v[20:23], v[64:67], v[48:51], v[20:23]
  v_mfma_f32_16x16x32_bf16 v[24:27], v[76:79], v[48:51], v[24:27]
  s_cmp_lg_u32 s60, 0
  s_cbranch_scc1 L_skipv
  buffer_load_dwordx4 v[128:131], v3, s[40:43], s53 offen offset:0 nt
  buffer_load_dwordx4 v[132:135], v3, s[40:43], s53 offen offset:128 nt
  buffer_load_dwordx4 v[136:139], v3, s[40:43], s53 offen offset:256 nt
  buffer_load_dwordx4 v[140:143], v4, s[40:43], s53 offen offset:0 nt
  buffer_load_dwordx4 v[144:147], v4, s[40:43], s53 offen offset:128 nt
  buffer_load_dwordx4 v[148:151], v4, s[40:43], s53 offen offset:256 nt
L_skipv:
  s_nop 4
  v_add_f32_dpp v12, v21, v20 row_ror:8 row_mask:0xf bank_mask:0x3
  v_add_f32_dpp v13, v25, v24 row_ror:8 row_mask:0xf bank_mask:0x3
  s_nop 0
  v_add_f32_dpp v12, v22, v23 row_ror:8 row_mask:0xf bank_mask:0xc
  v_add_f32_dpp v13, v26, v27 row_ror:8 row_mask:0xf bank_mask:0xc
  v_cvt_pk_bf16_f32 v13, v12, v13
  v_lshlrev_b32 v12, 16, v13
  v_and_b32 v13, 0xffff0000, v13
  v_mul_f32 v12, 0x3d93cd3a, v12
  v_mul_f32 v13, 0x3d93cd3a, v13
  v_cvt_pk_bf16_f32 v13, v12, v13
  v_lshlrev_b32 v12, 16, v13
  v_and_b32 v13, 0xffff0000, v13
  v_max_f32 v15, v12, v13
  v_cmp_gt_f32 vcc, v15, v9
  s_cbranch_vccz L_nr_8
  s_call_b64 s[66:67], L_rare
L_nr_8:
  v_fmamk_f32 v12, v12, 0x3fb8aa3b, v10
  v_fmamk_f32 v13, v13, 0x3fb8aa3b, v10
  v_exp_f32 v12, v12
  v_exp_f32 v13, v13
  v_add_f32 v11, v11, v12
  v_cvt_pk_bf16_f32 v14, v12, v12
  v_cvt_pk_bf16_f32 v15, v13, v13
  v_add_f32 v11, v11, v13
  v_and_b32 v20, v14, v5
  v_and_b32 v21, v14, v6
  v_and_b32 v22, v14, v7
  v_and_b32 v23, v14, v8
  v_and_b32 v24, v15, v5
  v_and_b32 v25, v15, v6
  v_and_b32 v26, v15, v7
  v_and_b32 v27, v15, v8
  s_waitcnt vmcnt(12)
  v_mfma_f32_16x16x32_bf16 v[28:31], v[20:23], v[80:83], v[28:31]
  v_mfma_f32_16x16x32_bf16 v[32:35], v[20:23], v[84:87], v[32:35]
  v_mfma_f32_16x16x32_bf16 v[36:39], v[20:23], v[88:91], v[36:39]
  v_mfma_f32_16x16x32_bf16 v[28:31], v[24:27], v[92:95], v[28:31]
  v_mfma_f32_16x16x32_bf16 v[32:35], v[24:27], v[96:99], v[32:35]
  v_mfma_f32_16x16x32_bf16 v[36:39], v[24:27], v[100:103], v[36:39]
  s_cmp_lg_u32 s55, 0
  s_cbranch_scc1 L_sdone
  s_waitcnt lgkmcnt(0)
  v_readfirstlane_b32 s56, v16
  s_nop 0
  s_cmp_eq_u32 s56, -1
  s_cbranch_scc1 L_rbw0
L_rbok0:
  s_add_u32 s57, s56, s52
  s_mul_i32 s57, s57, 6144
  s_cmp_eq_u32 s56, 2147483647
  s_cselect_b32 s53, 0, s57
  s_cselect_b32 s38, 0, s38
  s_cselect_b32 s42, 0, s42
  s_cselect_b32 s57, 0, 4
  s_addc_u32 s55, s55, 0
  s_add_u32 s54, s54, s57
  v_mov_b32 v17, s54
  buffer_load_dwordx4 v[56:59], v1, s[36:39], s53 offen offset:0 nt
  buffer_load_dwordx4 v[60:63], v1, s[36:39], s53 offen offset:128 nt
  buffer_load_dwordx4 v[64:67], v1, s[36:39], s53 offen offset:256 nt
  buffer_load_dwordx4 v[68:71], v2, s[36:39], s53 offen offset:0 nt
  buffer_load_dwordx4 v[72:75], v2, s[36:39], s53 offen offset:128 nt
  buffer_load_dwordx4 v[76:79], v2, s[36:39], s53 offen offset:256 nt
  ds_read_b32 v16, v17
  ds_write_b32 v18, v17
  s_waitcnt vmcnt(12)
  v_mfma_f32_16x16x32_bf16 v[20:23], v[104:107], v[40:43], 0
  v_mfma_f32_16x16x32_bf16 v[24:27], v[116:119], v[40:43], 0
  v_mfma_f32_16x16x32_bf16 v[20:23], v[108:111], v[44:47], v[20:23]
  v_mfma_f32_16x16x32_bf16 v[24:27], v[120:123], v[44:47], v[24:27]
  v_mfma_f32_16x16x32_bf16 v[20:23], v[112:115], v[48:51], v[20:23]
  v_mfma_f32_16x16x32_bf16 v[24:27], v[124:127], v[48:51], v[24:27]
  buffer_load_dwordx4 v[80:83], v3, s[40:43], s53 offen offset:0 nt
  buffer_load_dwordx4 v[84:87], v3, s[40:43], s53 offen offset:128 nt
  buffer_load_dwordx4 v[88:91], v3, s[40:43], s53 offen offset:256 nt
  buffer_load_dwordx4 v[92:95], v4, s[40:43], s53 offen offset:0 nt
  buffer_load_dwordx4 v[96:99], v4, s[40:43], s53 offen offset:128 nt
  buffer_load_dwordx4 v[100:103], v4, s[40:43], s53 offen offset:256 nt
  s_nop 0
  v_add_f32_dpp v12, v21, v20 row_ror:8 row_mask:0xf bank_mask:0x3
  v_add_f32_dpp v13, v25, v24 row_ror:8 row_mask:0xf bank_mask:0x3
  s_nop 0
  v_add_f32_dpp v12, v22, v23 row_ror:8 row_mask:0xf bank_mask:0xc
  v_add_f32_dpp v13, v26, v27 row_ror:8 row_mask:0xf bank_mask:0xc
  v_cvt_pk_bf16_f32 v13, v12, v13
  v_lshlrev_b32 v12, 16, v13
  v_and_b32 v13, 0xffff0000, v13
  v_mul_f32 v12, 0x3d93cd3a, v12
  v_mul_f32 v13, 0x3d93cd3a, v13
  v_cvt_pk_bf16_f32 v13, v12, v13
  v_lshlrev_b32 v12, 16, v13
  v_and_b32 v13, 0xffff0000, v13
  v_max_f32 v15, v12, v13
  v_cmp_gt_f32 vcc, v15, v9
  s_cbranch_vccz L_nr_9
  s_call_b64 s[66:67], L_rare
L_nr_9:
  v_fmamk_f32 v12, v12, 0x3fb8aa3b, v10
  v_fmamk_f32 v13, v13, 0x3fb8aa3b, v10
  v_exp_f32 v12, v12
  v_exp_f32 v13, v13
  v_add_f32 v11, v11, v12
  v_cvt_pk_bf16_f32 v14, v12, v12
  v_cvt_pk_bf16_f32 v15, v13, v13
  v_add_f32 v11, v11, v13
  v_and_b32 v20, v14, v5
  v_and_b32 v21, v14, v6
  v_and_b32 v22, v14, v7
  v_and_b32 v23, v14, v8
  v_and_b32 v24, v15, v5
  v_and_b32 v25, v15, v6
  v_and_b32 v26, v15, v7
  v_and_b32 v27, v15, v8
  s_waitcnt vmcnt(12)
  v_mfma_f32_16x16x32_bf16 v[28:31], v[20:23], v[128:131], v[28:31]
  v_mfma_f32_16x16x32_bf16 v[32:35], v[20:23], v[132:135], v[32:35]
  v_mfma_f32_16x16x32_bf16 v[36:39], v[20:23], v[136:139], v[36:39]
  v_mfma_f32_16x16x32_bf16 v[28:31], v[24:27], v[140:143], v[28:31]
  v_mfma_f32_16x16x32_bf16 v[32:35], v[24:27], v[144:147], v[32:35]
  v_mfma_f32_16x16x32_bf16 v[36:39], v[24:27], v[148:151], v[36:39]
  s_cmp_lg_u32 s55, 0
  s_cbranch_scc1 L_sdone
  s_waitcnt lgkmcnt(0)
  v_readfirstlane_b32 s56, v16
  s_nop 0
  s_cmp_eq_u32 s56, -1
  s_cbranch_scc1 L_rbw1
L_rbok1:
  s_add_u32 s57, s56, s52
  s_mul_i32 s57, s57, 6144
  s_cmp_eq_u32 s56, 2147483647
  s_cselect_b32 s53, 0, s57
  s_cselect_b32 s38, 0, s38
  s_cselect_b32 s42, 0, s42
  s_cselect_b32 s57, 0, 4
  s_addc_u32 s55, s55, 0
  s_add_u32 s54, s54, s57
  v_mov_b32 v17, s54
  buffer_load_dwordx4 v[104:107], v1, s[36:39], s53 offen offset:0 nt
  buffer_load_dwordx4 v[108:111], v1, s[36:39], s53 offen offset:128 nt
  buffer_load_dwordx4 v[112:115], v1, s[36:39], s53 offen offset:256 nt
  buffer_load_dwordx4 v[116:119], v2, s[36:39], s53 offen offset:0 nt
  buffer_load_dwordx4 v[120:123], v2, s[36:39], s53 offen offset:128 nt
  buffer_load_dwordx4 v[124:127], v2, s[36:39], s53 offen offset:256 nt
  ds_read_b32 v16, v17
  ds_write_b32 v18, v17
  s_cmp_eq_u32 s60, 0
  s_cbranch_scc1 L_loop
  s_waitcnt vmcnt(18)
  v_mfma_f32_16x16x32_bf16 v[20:23], v[152:155], v[40:43], 0
  v_mfma_f32_16x16x32_bf16 v[24:27], v[164:167], v[40:43], 0
  v_mfma_f32_16x16x32_bf16 v[20:23], v[156:159], v[44:47], v[20:23]
  v_mfma_f32_16x16x32_bf16 v[24:27], v[168:171], v[44:47], v[24:27]
  v_mfma_f32_16x16x32_bf16 v[20:23], v[160:163], v[48:51], v[20:23]
  v_mfma_f32_16x16x32_bf16 v[24:27], v[172:175], v[48:51], v[24:27]
  s_nop 6
  v_add_f32_dpp v12, v21, v20 row_ror:8 row_mask:0xf bank_mask:0x3
  v_add_f32_dpp v13, v25, v24 row_ror:8 row_mask:0xf bank_mask:0x3
  s_nop 0
  v_add_f32_dpp v12, v22, v23 row_ror:8 row_mask:0xf bank_mask:0xc
  v_add_f32_dpp v13, v26, v27 row_ror:8 row_mask:0xf bank_mask:0xc
  v_cvt_pk_bf16_f32 v13, v12, v13
  v_lshlrev_b32 v12, 16, v13
  v_and_b32 v13, 0xffff0000, v13
  v_mul_f32 v12, 0x3d93cd3a, v12
  v_mul_f32 v13, 0x3d93cd3a, v13
  v_cvt_pk_bf16_f32 v13, v12, v13
  v_lshlrev_b32 v12, 16, v13
  v_and_b32 v13, 0xffff0000, v13
  v_max_f32 v15, v12, v13
  v_cmp_gt_f32 vcc, v15, v9
  s_cbranch_vccz L_nr_10
  s_call_b64 s[66:67], L_rare
L_nr_10:
  v_fmamk_f32 v12, v12, 0x3fb8aa3b, v10
  v_fmamk_f32 v13, v13, 0x3fb8aa3b, v10
  v_exp_f32 v12, v12
  v_exp_f32 v13, v13
  v_add_f32 v11, v11, v12
  v_cvt_pk_bf16_f32 v14, v12, v12
  v_cvt_pk_bf16_f32 v15, v13, v13
  v_add_f32 v11, v11, v13
  v_and_b32 v20, v14, v5
  v_and_b32 v21, v14, v6
  v_and_b32 v22, v14, v7
  v_and_b32 v23, v14, v8
  v_and_b32 v24, v15, v5
  v_and_b32 v25, v15, v6
  v_and_b32 v26, v15, v7
  v_and_b32 v27, v15, v8
  v_mfma_f32_16x16x32_bf16 v[28:31], v[20:23], v[176:179], v[28:31]
  v_mfma_f32_16x16x32_bf16 v[32:35], v[20:23], v[180:183], v[32:35]
  v_mfma_f32_16x16x32_bf16 v[36:39], v[20:23], v[184:187], v[36:39]
  v_mfma_f32_16x16x32_bf16 v[28:31], v[24:27], v[188:191], v[28:31]
  v_mfma_f32_16x16x32_bf16 v[32:35], v[24:27], v[192:195], v[32:35]
  v_mfma_f32_16x16x32_bf16 v[36:39], v[24:27], v[196:199], v[36:39]
  s_mov_b32 s60, 3
  v_lshlrev_b32 v52, 4, v0
  v_add_u32 v52, s59, v52
L_det:
  v_mfma_f32_16x16x32_bf16 v[20:23], v[200:203], v[40:43], 0
  v_mfma_f32_16x16x32_bf16 v[24:27], v[212:215], v[40:43], 0
  v_mfma_f32_16x16x32_bf16 v[20:23], v[204:207], v[44:47], v[20:23]
  v_mfma_f32_16x16x32_bf16 v[24:27], v[216:219], v[44:47], v[24:27]
  v_mfma_f32_16x16x32_bf16 v[20:23], v[208:211], v[48:51], v[20:23]
  v_mfma_f32_16x16x32_bf16 v[24:27], v[220:223], v[48:51], v[24:27]
  s_nop 6
  v_add_f32_dpp v12, v21, v20 row_ror:8 row_mask:0xf bank_mask:0x3
  v_add_f32_dpp v13, v25, v24 row_ror:8 row_mask:0xf bank_mask:0x3
  s_nop 0
  v_add_f32_dpp v12, v22, v23 row_ror:8 row_mask:0xf bank_mask:0xc
  v_add_f32_dpp v13, v26, v27 row_ror:8 row_mask:0xf bank_mask:0xc
  v_cvt_pk_bf16_f32 v13, v12, v13
  v_lshlrev_b32 v12, 16, v13
  v_and_b32 v13, 0xffff0000, v13
  v_mul_f32 v12, 0x3d93cd3a, v12
  v_mul_f32 v13, 0x3d93cd3a, v13
  v_cvt_pk_bf16_f32 v13, v12, v13
  v_lshlrev_b32 v12, 16, v13
  v_and_b32 v13, 0xffff0000, v13
  v_max_f32 v15, v12, v13
  v_cmp_gt_f32 vcc, v15, v9
  s_cbranch_vccz L_nr_11
  s_call_b64 s[66:67], L_rare
L_nr_11:
  v_fmamk_f32 v12, v12, 0x3fb8aa3b, v10
  v_fmamk_f32 v13, v13, 0x3fb8aa3b, v10
  v_exp_f32 v12, v12
  v_exp_f32 v13, v13
  v_add_f32 v11, v11, v12
  v_cvt_pk_bf16_f32 v14, v12, v12
  v_cvt_pk_bf16_f32 v15, v13, v13
  v_add_f32 v11, v11, v13
  v_and_b32 v20, v14, v5
  v_and_b32 v21, v14, v6
  v_and_b32 v22, v14, v7
  v_and_b32 v23, v14, v8
  v_and_b32 v24, v15, v5
  v_and_b32 v25, v15, v6
  v_and_b32 v26, v15, v7
  v_and_b32 v27, v15, v8
  v_mfma_f32_16x16x32_bf16 v[28:31], v[20:23], v[224:227], v[28:31]
  v_mfma_f32_16x16x32_bf16 v[32:35], v[20:23], v[228:231], v[32:35]
  v_mfma_f32_16x16x32_bf16 v[36:39], v[20:23], v[232:235], v[36:39]
  v_mfma_f32_16x16x32_bf16 v[28:31], v[24:27], v[236:239], v[28:31]
  v_mfma_f32_16x16x32_bf16 v[32:35], v[24:27], v[240:243], v[32:35]
  v_mfma_f32_16x16x32_bf16 v[36:39], v[24:27], v[244:247], v[36:39]
  s_cmp_eq_u32 s60, 0
  s_cbranch_scc1 L_detx
  ds_read_b128 v[200:203], v52 offset:0
  ds_read_b128 v[204:207], v52 offset:1024
  ds_read_b128 v[208:211], v52 offset:2048
  ds_read_b128 v[212:215], v52 offset:3072
  ds_read_b128 v[216:219], v52 offset:4096
  ds_read_b128 v[220:223], v52 offset:5120
  ds_read_b128 v[224:227], v52 offset:6144
  ds_read_b128 v[228:231], v52 offset:7168
  ds_read_b128 v[232:235], v52 offset:8192
  ds_read_b128 v[236:239], v52 offset:9216
  ds_read_b128 v[240:243], v52 offset:10240
  ds_read_b128 v[244:247], v52 offset:11264
  v_add_u32 v52, 12288, v52
  s_sub_u32 s60, s60, 1
  s_waitcnt lgkmcnt(0)
  s_branch L_det
L_detx:
  v_mov_b32 v52, 1
  ds_write_b32 v18, v52 offset:32
  s_branch L_loop
L_rbw0:
L_rbv0:
  s_sub_u32 s68, s68, 1
  s_cbranch_scc1 L_fail
  ds_read_b32 v16, v17
  s_waitcnt lgkmcnt(0)
  v_readfirstlane_b32 s56, v16
  s_nop 0
  s_cmp_eq_u32 s56, -1
  s_cbranch_scc1 L_rbv0
  s_branch L_rbok0
L_rbw1:
L_rbv1:
  s_sub_u32 s68, s68, 1
  s_cbranch_scc1 L_fail
  ds_read_b32 v16, v17
  s_waitcnt lgkmcnt(0)
  v_readfirstlane_b32 s56, v16
  s_nop 0
  s_cmp_eq_u32 s56, -1
  s_cbranch_scc1 L_rbv1
  s_branch L_rbok1
L_rare:
  v_max_f32_dpp v15, v15, v15 row_ror:8 row_mask:0xf bank_mask:0xf
  s_nop 1
  v_max_f32_dpp v15, v15, v15 row_bcast:15 row_mask:0xa bank_mask:0xf
  s_nop 1
  v_max_f32_dpp v15, v15, v15 row_bcast:31 row_mask:0xc bank_mask:0xf
  s_nop 0
  v_readlane_b32 s57, v15, 63
  s_nop 1
  v_mov_b32 v9, s57
  v_mul_f32 v15, 0xbfb8aa3b, v9
  v_sub_f32 v14, v15, v10
  v_exp_f32 v14, v14
  v_mov_b32 v10, v15
  v_mul_f32 v11, v11, v14
  v_mul_f32 v28, v28, v14
  v_mul_f32 v29, v29, v14
  v_mul_f32 v30, v30, v14
  v_mul_f32 v31, v31, v14
  v_mul_f32 v32, v32, v14
  v_mul_f32 v33, v33, v14
  v_mul_f32 v34, v34, v14
  v_mul_f32 v35, v35, v14
  v_mul_f32 v36, v36, v14
  v_mul_f32 v37, v37, v14
  v_mul_f32 v38, v38, v14
  v_mul_f32 v39, v39, v14
  s_setpc_b64 s[66:67]
L_sdone:
  v_add_f32_dpp v11, v11, v11 row_ror:8 row_mask:0xf bank_mask:0xf
  v_and_b32 v12, 7, v0
  v_lshlrev_b32 v12, 5, v12
  v_add_f32_dpp v11, v11, v11 row_bcast:15 row_mask:0xa bank_mask:0xf
  v_bfe_u32 v13, v0, 4, 1
  v_lshl_add_u32 v12, v13, 4, v12
  v_add_f32_dpp v11, v11, v11 row_bcast:31 row_mask:0xc bank_mask:0xf
  v_lshrrev_b32 v13, 5, v0
  v_mul_u32_u24 v13, 768, v13
  s_mul_i32 s57, s52, 1536
  v_add3_u32 v12, v12, v13, s57
  s_lshl_b32 s57, s52, 3
  v_mov_b32 v13, s57
  s_mov_b32 exec_lo, 0x00ff00ff
  s_mov_b32 exec_hi, 0xff00ff00
  ds_write_b128 v12, v[28:31] offset:5120
  ds_write_b128 v12, v[32:35] offset:5376
  ds_write_b128 v12, v[36:39] offset:5632
  s_mov_b32 exec_lo, 0
  s_mov_b32 exec_hi, 0x80000000
  ds_write_b64 v13, v[10:11] offset:11264
  s_waitcnt lgkmcnt(0)
  s_barrier
  s_endpgm
L_fail:
  s_mov_b64 exec, 1
  s_lshl_b32 s52, s2, 3
  s_add_u32 s52, s52, s3
  s_or_b32 s52, s52, 0xdead0000
  v_mov_b32 v1, 0
  v_mov_b32 v2, s52
  global_store_dword v1, v2, s[28:29]
L_exit:
  s_endpgm
.section .rodata,"a"
.p2align 6
.amdhsa_kernel adaLN_cond__mha_block_cached__glu_gated_geglu__decode_kernel
  .amdhsa_next_free_vgpr 256
  .amdhsa_next_free_sgpr 102
  .amdhsa_accum_offset 256
  .amdhsa_group_segment_fixed_size 0
  .amdhsa_kernarg_size 112
  .amdhsa_user_sgpr_count 2
  .amdhsa_user_sgpr_kernarg_segment_ptr 1
  .amdhsa_system_sgpr_workgroup_id_x 1
  .amdhsa_float_denorm_mode_32 3
.end_amdhsa_kernel
```
